```python
import torch

def _softmax(x, axis=-1):
    return torch.softmax(x, dim=axis)
def _gelu(x):
    return torch.nn.functional.gelu(x, approximate="tanh")
def _silu(x):
    return torch.nn.functional.silu(x)
def _sigmoid(x):
    return torch.sigmoid(x)
def _layernorm(x, axis=-1, eps=1e-5):
    m = x.mean(dim=axis, keepdim=True)
    v = x.var(dim=axis, keepdim=True, unbiased=False)
    return (x - m) / torch.sqrt(v + eps)
def _scatter_add(tgt, idx, src, axis=0):
    return tgt.clone().index_add_(axis, idx, src)
def _segment_sum(src, seg, n):
    out = torch.zeros((n,) + src.shape[1:], dtype=src.dtype)
    return out.index_add_(0, seg, src)
def _pad(x, pw):
    flat = tuple(v for pair in reversed(pw) for v in pair)
    return torch.nn.functional.pad(x, flat)

kernel_name = 'standalone__mixer_token_mlp__prompt'

def setup_inputs():

    _w = (lambda a: (lambda t: t.to(torch.bfloat16) if t.is_floating_point() else t)(torch.as_tensor(a)))
    B, S, D, F = 1, 2048, 640, 1728
    return {
        "x": _w((lambda *s: torch.randn(*s, dtype=torch.bfloat16) * 0.05)(B, S, D)),
        "w1": _w((lambda *s: torch.randn(*s, dtype=torch.bfloat16) * 0.2)(S, F) * (S ** -0.5)),
        "b1": _w((lambda *s: torch.randn(*s, dtype=torch.bfloat16) * 1.6)(F) * 0.02),
        "w2": _w((lambda *s: torch.randn(*s, dtype=torch.bfloat16) * 0.05)(F, S) * (F ** -0.5)),
        "b2": _w((lambda *s: torch.randn(*s, dtype=torch.bfloat16) * 0.1)(S) * 0.02),
    }

def reference(x, w1, b1, w2, b2):
    B, S, D = x.shape
    h = _layernorm(x, axis=-1)
    u = torch.einsum("bsd,sf->bdf", h, w1) + b1
    u = _gelu(u)
    y = torch.einsum("bdf,fs->bds", u, w2) + b2
    return (lambda x, *d: x.permute(*d))(y, 0, 2, 1)
```

```asm
; @launch grid=(256,1,1) block=(256,1,1) lds=163840
.amdgcn_target "amdgcn-amd-amdhsa--gfx950"
.text
.globl standalone__mixer_token_mlp__prompt_kernel
.p2align 8
.type standalone__mixer_token_mlp__prompt_kernel,@function
standalone__mixer_token_mlp__prompt_kernel:
s_cmp_ge_u32 s2, 256
s_cbranch_scc1 L_end
s_load_dwordx16 s[48:63], s[0:1], 0
v_and_b32 v1, 63, v0
v_lshrrev_b32 v12, 6, v0
v_lshlrev_b32 v2, 4, v1
v_readfirstlane_b32 s3, v12
v_add_u32 v3, 0x1000, v2
s_getpc_b64 s[42:43]
L_pf_base:
s_nop 2
s_lshr_b32 s44, s2, 3
s_and_b32 s44, s44, 7
s_lshl_b32 s44, s44, 2
s_add_u32 s44, s44, s3
s_min_u32 s44, s44, (L_code_end - L_pf_base) / 1024 - 1
s_lshl_b32 s44, s44, 10
s_add_u32 s42, s42, s44
s_addc_u32 s43, s43, 0
global_load_dwordx4 v[124:127], v2, s[42:43]
s_and_b32 s42, s2, 1
s_lshl_b32 s42, s42, 2
s_bfe_u32 s44, s2, 0x20003
s_add_u32 s4, s42, s44
s_lshr_b32 s43, s2, 5
s_bfe_u32 s45, s2, 0x20001
s_lshl_b32 s44, s45, 3
s_cmp_eq_u32 s43, 7
s_cselect_b32 s42, 3, s43
s_cmp_eq_u32 s43, 3
s_cselect_b32 s42, 7, s42
s_add_u32 s6, s44, s42
s_mov_b32 s94, s4
s_mul_i32 s44, s45, 7
s_add_u32 s5, s44, s43
s_cmp_eq_u32 s45, 3
s_cselect_b32 s44, 6, 7
s_cmp_lt_u32 s43, s44
s_cselect_b32 s7, 1, 0
s_mul_i32 s46, s3, 36864
v_lshrrev_b32 v12, 5, v1
v_mul_u32_u24 v12, 1280, v12
v_and_b32 v13, 31, v1
v_lshl_add_u32 v14, v13, 4, v12
v_lshl_add_u32 v15, v13, 3, v12
v_lshrrev_b32 v12, 3, v1
v_and_b32 v13, 2, v12
v_mul_u32_u24 v12, 3456, v12
v_and_b32 v6, 7, v1
v_xor_b32 v13, v13, v6
v_lshl_add_u32 v4, v13, 4, v12
v_xor_b32 v13, 4, v13
v_lshl_add_u32 v5, v13, 4, v12
v_add_u32 v5, 27648, v5
v_add_u32 v6, 55296, v4
v_add_u32 v7, 55296, v5
s_lshl_b32 s42, s2, 3
s_lshl_b32 s43, s3, 1
s_add_u32 s42, s42, s43
s_mul_i32 s47, s42, 1280
s_waitcnt lgkmcnt(0)
s_mov_b32 s8, s48
s_and_b32 s9, s49, 0xffff
s_mov_b32 s10, 2621440
s_mov_b32 s11, 0x00020000
buffer_load_dwordx4 v[16:19], v14, s[8:11], s47 offen
buffer_load_dwordx4 v[20:23], v14, s[8:11], s47 offen offset:512
buffer_load_dwordx2 v[24:25], v15, s[8:11], s47 offen offset:1024
s_mov_b32 s12, s50
s_and_b32 s13, s51, 0xffff
s_mov_b32 s14, 7077888
s_mov_b32 s15, 0x00020000
s_mov_b32 s20, s52
s_and_b32 s21, s53, 0xffff
s_mov_b32 s22, 3456
s_mov_b32 s23, 0x00020000
s_mov_b32 s16, s54
s_and_b32 s17, s55, 0xffff
s_mov_b32 s18, 7077888
s_mov_b32 s19, 0x00020000
s_mov_b32 s32, s60
s_and_b32 s33, s61, 0xffff
s_mov_b32 s34, 256
s_mov_b32 s35, 0x00020000
s_mov_b32 s36, s62
s_and_b32 s37, s63, 0xffff
s_mov_b32 s38, 268435456
s_mov_b32 s39, 0x00020000
s_mov_b32 s24, s56
s_and_b32 s25, s57, 0xffff
s_mov_b32 s26, 4096
s_mov_b32 s27, 0x00020000
s_mov_b32 s28, s58
s_and_b32 s29, s59, 0xffff
s_mov_b32 s30, 2621440
s_mov_b32 s31, 0x00020000
s_mov_b32 s42, s94
s_and_b32 s42, s42, 3
s_mul_i32 s42, s42, 16
s_lshr_b32 s52, s42, 2
s_lshl_b32 s42, s3, 4
s_mul_i32 s48, s42, 110592
s_lshl_b32 s42, s5, 7
s_add_u32 s48, s48, s42
s_cmp_eq_u32 s7, 0
s_cselect_b32 s48, 268435456, s48
s_add_u32 s49, s48, 1769472
s_mul_i32 s96, s52, 110592
s_add_u32 s96, s96, s48
s_add_u32 m0, s46, 0
s_nop 0
s_or_b32 s42, s2, s3
s_cmp_lg_u32 s42, 0
s_cbranch_scc1 L_no_nonce
s_memrealtime s[42:43]
s_waitcnt lgkmcnt(0)
s_or_b32 s43, s43, 0x40000000
v_mov_b32 v12, s42
v_mov_b32 v13, s43
v_mov_b32 v112, 0
buffer_store_dwordx2 v[12:13], v112, s[32:35], 0 offen sc1
L_no_nonce:
v_and_b32 v100, 31, v1
v_lshrrev_b32 v101, 5, v1
v_lshlrev_b32 v101, 1, v101
s_lshl_b32 s42, s3, 2
s_add_u32 s42, s42, 147456
v_and_b32 v102, 7, v100
v_xor_b32 v102, v102, v101
v_lshlrev_b32 v103, 7, v100
buffer_load_dwordx4 v4, s[12:15], s96 offen lds
s_add_u32 m0, s46, 1024
v_add_u32 v103, s42, v103
v_lshrrev_b32 v107, 1, v100
v_lshlrev_b32 v108, 7, v107
v_add_u32 v108, s42, v108
v_xor_b32 v104, 0, v102
v_lshl_add_u32 v80, v104, 4, v103
v_xor_b32 v104, 1, v102
v_lshl_add_u32 v81, v104, 4, v103
v_xor_b32 v104, 4, v102
buffer_load_dwordx4 v5, s[12:15], s96 offen lds
s_add_u32 m0, s46, 2048
v_lshl_add_u32 v82, v104, 4, v103
v_xor_b32 v104, 5, v102
v_lshl_add_u32 v83, v104, 4, v103
v_xor_b32 v104, 0, v102
v_lshl_add_u32 v84, v104, 4, v103
v_add_u32 v84, 4096, v84
buffer_load_dwordx4 v6, s[12:15], s96 offen lds
s_add_u32 m0, s46, 3072
v_xor_b32 v104, 1, v102
v_lshl_add_u32 v85, v104, 4, v103
v_add_u32 v85, 4096, v85
v_xor_b32 v104, 4, v102
v_lshl_add_u32 v86, v104, 4, v103
v_add_u32 v86, 4096, v86
buffer_load_dwordx4 v7, s[12:15], s96 offen lds
s_add_u32 m0, s46, 4096
s_add_u32 s96, s96, 110592
s_cmp_eq_u32 s96, s49
s_cselect_b32 s96, s48, s96
v_xor_b32 v104, 5, v102
v_lshl_add_u32 v87, v104, 4, v103
v_add_u32 v87, 4096, v87
v_and_b32 v105, 1, v100
v_lshl_add_u32 v105, v105, 2, v101
v_and_b32 v106, 7, v107
buffer_load_dwordx4 v4, s[12:15], s96 offen lds
s_add_u32 m0, s46, 5120
v_xor_b32 v105, v105, v106
v_add_u32 v108, 8192, v108
v_lshl_add_u32 v88, v105, 4, v108
v_xor_b32 v105, 1, v105
v_lshl_add_u32 v89, v105, 4, v108
v_add_u32 v100, 0, v0
buffer_load_dwordx4 v5, s[12:15], s96 offen lds
s_add_u32 m0, s46, 6144
v_lshrrev_b32 v101, 3, v100
v_xor_b32 v101, v101, v100
v_and_b32 v101, 7, v101
v_and_b32 v102, 0x3f8, v100
v_or_b32 v101, v101, v102
v_lshrrev_b32 v102, 4, v101
buffer_load_dwordx4 v6, s[12:15], s96 offen lds
s_add_u32 m0, s46, 7168
v_mul_u32_u24 v103, 205, v102
v_lshrrev_b32 v103, 10, v103
v_mul_u32_u24 v103, 315, v103
v_add_u32 v103, v103, v102
v_lshlrev_b32 v103, 10, v103
v_and_b32 v101, 15, v101
buffer_load_dwordx4 v7, s[12:15], s96 offen lds
s_add_u32 m0, s46, 8192
s_add_u32 s96, s96, 110592
s_cmp_eq_u32 s96, s49
s_cselect_b32 s96, s48, s96
v_lshl_add_u32 v92, v101, 4, v103
v_add_u32 v100, 256, v0
v_lshrrev_b32 v101, 3, v100
v_xor_b32 v101, v101, v100
v_and_b32 v101, 7, v101
v_and_b32 v102, 0x3f8, v100
v_or_b32 v101, v101, v102
v_lshrrev_b32 v102, 4, v101
v_mul_u32_u24 v103, 205, v102
v_lshrrev_b32 v103, 10, v103
v_mul_u32_u24 v103, 315, v103
v_add_u32 v103, v103, v102
v_lshlrev_b32 v103, 10, v103
v_and_b32 v101, 15, v101
v_lshl_add_u32 v93, v101, 4, v103
v_add_u32 v100, 512, v0
v_lshrrev_b32 v101, 3, v100
v_xor_b32 v101, v101, v100
v_and_b32 v101, 7, v101
v_and_b32 v102, 0x3f8, v100
v_or_b32 v101, v101, v102
v_lshrrev_b32 v102, 4, v101
v_mul_u32_u24 v103, 205, v102
v_lshrrev_b32 v103, 10, v103
v_mul_u32_u24 v103, 315, v103
v_add_u32 v103, v103, v102
v_lshlrev_b32 v103, 10, v103
v_and_b32 v101, 15, v101
v_lshl_add_u32 v94, v101, 4, v103
v_lshlrev_b32 v95, 4, v0
v_add_u32 v95, 147456, v95
s_lshr_b32 s42, s2, 2
s_mul_i32 s42, s42, 5120
s_and_b32 s43, s2, 3
s_lshl_b32 s43, s43, 8
s_add_u32 s54, s42, s43
v_lshrrev_b32 v112, 4, v1
v_bfe_u32 v113, v1, 2, 2
v_lshl_add_u32 v114, v112, 3, v113
v_lshlrev_b32 v114, 7, v114
v_and_b32 v115, 1, v1
v_lshl_add_u32 v114, v115, 3, v114
v_add_u32 v114, s46, v114
v_and_b32 v112, 1, v112
v_lshlrev_b32 v112, 2, v112
v_and_b32 v113, 2, v113
v_or_b32 v112, v112, v113
v_bfe_u32 v113, v1, 1, 1
v_xor_b32 v112, v112, v113
s_add_u32 s42, s3, 0
s_and_b32 s42, s42, 3
s_lshl_b32 s42, s42, 1
v_xor_b32 v113, s42, v112
v_lshl_add_u32 v8, v113, 4, v114
s_add_u32 s42, s3, 1
s_and_b32 s42, s42, 3
s_lshl_b32 s42, s42, 1
v_xor_b32 v113, s42, v112
v_lshl_add_u32 v9, v113, 4, v114
s_add_u32 s42, s3, 2
s_and_b32 s42, s42, 3
s_lshl_b32 s42, s42, 1
v_xor_b32 v113, s42, v112
v_lshl_add_u32 v10, v113, 4, v114
s_add_u32 s42, s3, 3
s_and_b32 s42, s42, 3
s_lshl_b32 s42, s42, 1
v_xor_b32 v113, s42, v112
v_lshl_add_u32 v11, v113, 4, v114
s_waitcnt vmcnt(8)
v_mov_b32 v118, 0
buffer_load_dwordx2 v[116:117], v118, s[32:35], 0 offen sc1
v_lshlrev_b32 v28, 16, v16
v_and_b32 v29, 0xffff0000, v16
v_lshlrev_b32 v30, 16, v17
v_and_b32 v31, 0xffff0000, v17
v_lshlrev_b32 v32, 16, v18
v_and_b32 v33, 0xffff0000, v18
v_lshlrev_b32 v34, 16, v19
v_and_b32 v35, 0xffff0000, v19
v_lshlrev_b32 v36, 16, v20
v_and_b32 v37, 0xffff0000, v20
v_lshlrev_b32 v38, 16, v21
v_and_b32 v39, 0xffff0000, v21
v_lshlrev_b32 v40, 16, v22
v_and_b32 v41, 0xffff0000, v22
v_lshlrev_b32 v42, 16, v23
v_and_b32 v43, 0xffff0000, v23
v_lshlrev_b32 v44, 16, v24
v_and_b32 v45, 0xffff0000, v24
v_lshlrev_b32 v46, 16, v25
v_and_b32 v47, 0xffff0000, v25
v_pk_add_f32 v[100:101], v[28:29], v[30:31]
v_pk_add_f32 v[102:103], v[32:33], v[34:35]
v_pk_add_f32 v[100:101], v[100:101], v[36:37]
v_pk_add_f32 v[102:103], v[102:103], v[38:39]
v_pk_add_f32 v[100:101], v[100:101], v[40:41]
v_pk_add_f32 v[102:103], v[102:103], v[42:43]
v_pk_add_f32 v[100:101], v[100:101], v[44:45]
v_pk_add_f32 v[102:103], v[102:103], v[46:47]
v_pk_add_f32 v[100:101], v[100:101], v[102:103]
v_add_f32 v104, v100, v101
s_nop 1
v_add_f32_dpp v104, v104, v104 quad_perm:[1,0,3,2] row_mask:0xf bank_mask:0xf
s_nop 1
v_add_f32_dpp v104, v104, v104 quad_perm:[2,3,0,1] row_mask:0xf bank_mask:0xf
s_nop 1
v_add_f32_dpp v104, v104, v104 row_half_mirror row_mask:0xf bank_mask:0xf
s_nop 1
v_add_f32_dpp v104, v104, v104 row_mirror row_mask:0xf bank_mask:0xf
v_mov_b32 v106, v104
s_nop 1
v_permlane16_swap_b32 v104, v106
s_nop 1
v_add_f32 v104, v104, v106
v_mul_f32 v104, 0x3acccccd, v104
v_mov_b32 v105, v104
v_pk_add_f32 v[48:49], v[28:29], v[104:105] neg_lo:[0,1] neg_hi:[0,1]
v_pk_add_f32 v[50:51], v[30:31], v[104:105] neg_lo:[0,1] neg_hi:[0,1]
v_pk_add_f32 v[52:53], v[32:33], v[104:105] neg_lo:[0,1] neg_hi:[0,1]
v_pk_add_f32 v[54:55], v[34:35], v[104:105] neg_lo:[0,1] neg_hi:[0,1]
v_pk_add_f32 v[56:57], v[36:37], v[104:105] neg_lo:[0,1] neg_hi:[0,1]
v_pk_add_f32 v[58:59], v[38:39], v[104:105] neg_lo:[0,1] neg_hi:[0,1]
v_pk_add_f32 v[60:61], v[40:41], v[104:105] neg_lo:[0,1] neg_hi:[0,1]
v_pk_add_f32 v[62:63], v[42:43], v[104:105] neg_lo:[0,1] neg_hi:[0,1]
v_pk_add_f32 v[64:65], v[44:45], v[104:105] neg_lo:[0,1] neg_hi:[0,1]
v_pk_add_f32 v[66:67], v[46:47], v[104:105] neg_lo:[0,1] neg_hi:[0,1]
v_pk_mul_f32 v[100:101], v[48:49], v[48:49]
v_pk_mul_f32 v[102:103], v[50:51], v[50:51]
v_pk_fma_f32 v[100:101], v[52:53], v[52:53], v[100:101]
v_pk_fma_f32 v[102:103], v[54:55], v[54:55], v[102:103]
v_pk_fma_f32 v[100:101], v[56:57], v[56:57], v[100:101]
v_pk_fma_f32 v[102:103], v[58:59], v[58:59], v[102:103]
v_pk_fma_f32 v[100:101], v[60:61], v[60:61], v[100:101]
v_pk_fma_f32 v[102:103], v[62:63], v[62:63], v[102:103]
v_pk_fma_f32 v[100:101], v[64:65], v[64:65], v[100:101]
v_pk_fma_f32 v[102:103], v[66:67], v[66:67], v[102:103]
v_pk_add_f32 v[100:101], v[100:101], v[102:103]
v_add_f32 v108, v100, v101
s_nop 1
v_add_f32_dpp v108, v108, v108 quad_perm:[1,0,3,2] row_mask:0xf bank_mask:0xf
s_nop 1
v_add_f32_dpp v108, v108, v108 quad_perm:[2,3,0,1] row_mask:0xf bank_mask:0xf
s_nop 1
v_add_f32_dpp v108, v108, v108 row_half_mirror row_mask:0xf bank_mask:0xf
s_nop 1
v_add_f32_dpp v108, v108, v108 row_mirror row_mask:0xf bank_mask:0xf
v_mov_b32 v106, v108
s_nop 1
v_permlane16_swap_b32 v108, v106
s_nop 1
v_add_f32 v108, v108, v106
v_mul_f32 v108, 0x3acccccd, v108
v_cvt_pk_bf16_f32 v108, v108, v108
v_and_b32 v108, 0xffff0000, v108
v_add_f32 v108, 0x3727c5ac, v108
v_cvt_pk_bf16_f32 v108, v108, v108
v_and_b32 v108, 0xffff0000, v108
v_sqrt_f32 v108, v108
s_nop 0
v_cvt_pk_bf16_f32 v108, v108, v108
v_and_b32 v108, 0xffff0000, v108
v_rcp_f32 v110, v108
v_cvt_pk_bf16_f32 v104, v104, v104
v_and_b32 v104, 0xffff0000, v104
v_mov_b32 v105, v104
v_mov_b32 v111, v110
v_pk_add_f32 v[48:49], v[28:29], v[104:105] neg_lo:[0,1] neg_hi:[0,1]
v_pk_add_f32 v[50:51], v[30:31], v[104:105] neg_lo:[0,1] neg_hi:[0,1]
v_pk_add_f32 v[52:53], v[32:33], v[104:105] neg_lo:[0,1] neg_hi:[0,1]
v_pk_add_f32 v[54:55], v[34:35], v[104:105] neg_lo:[0,1] neg_hi:[0,1]
v_pk_add_f32 v[56:57], v[36:37], v[104:105] neg_lo:[0,1] neg_hi:[0,1]
v_pk_add_f32 v[58:59], v[38:39], v[104:105] neg_lo:[0,1] neg_hi:[0,1]
v_pk_add_f32 v[60:61], v[40:41], v[104:105] neg_lo:[0,1] neg_hi:[0,1]
v_pk_add_f32 v[62:63], v[42:43], v[104:105] neg_lo:[0,1] neg_hi:[0,1]
v_pk_add_f32 v[64:65], v[44:45], v[104:105] neg_lo:[0,1] neg_hi:[0,1]
v_pk_add_f32 v[66:67], v[46:47], v[104:105] neg_lo:[0,1] neg_hi:[0,1]
v_cvt_pk_bf16_f32 v68, v48, v49
v_cvt_pk_bf16_f32 v69, v50, v51
v_cvt_pk_bf16_f32 v70, v52, v53
v_cvt_pk_bf16_f32 v71, v54, v55
v_cvt_pk_bf16_f32 v72, v56, v57
v_cvt_pk_bf16_f32 v73, v58, v59
v_cvt_pk_bf16_f32 v74, v60, v61
v_cvt_pk_bf16_f32 v75, v62, v63
v_cvt_pk_bf16_f32 v76, v64, v65
v_cvt_pk_bf16_f32 v77, v66, v67
v_lshlrev_b32 v48, 16, v68
v_and_b32 v49, 0xffff0000, v68
v_lshlrev_b32 v50, 16, v69
v_and_b32 v51, 0xffff0000, v69
v_lshlrev_b32 v52, 16, v70
v_and_b32 v53, 0xffff0000, v70
v_lshlrev_b32 v54, 16, v71
v_and_b32 v55, 0xffff0000, v71
v_lshlrev_b32 v56, 16, v72
v_and_b32 v57, 0xffff0000, v72
v_lshlrev_b32 v58, 16, v73
v_and_b32 v59, 0xffff0000, v73
v_lshlrev_b32 v60, 16, v74
v_and_b32 v61, 0xffff0000, v74
v_lshlrev_b32 v62, 16, v75
v_and_b32 v63, 0xffff0000, v75
v_lshlrev_b32 v64, 16, v76
v_and_b32 v65, 0xffff0000, v76
v_lshlrev_b32 v66, 16, v77
v_and_b32 v67, 0xffff0000, v77
v_pk_mul_f32 v[48:49], v[48:49], v[110:111]
v_pk_mul_f32 v[50:51], v[50:51], v[110:111]
v_pk_mul_f32 v[52:53], v[52:53], v[110:111]
v_pk_mul_f32 v[54:55], v[54:55], v[110:111]
v_pk_mul_f32 v[56:57], v[56:57], v[110:111]
v_pk_mul_f32 v[58:59], v[58:59], v[110:111]
v_pk_mul_f32 v[60:61], v[60:61], v[110:111]
v_pk_mul_f32 v[62:63], v[62:63], v[110:111]
v_pk_mul_f32 v[64:65], v[64:65], v[110:111]
v_pk_mul_f32 v[66:67], v[66:67], v[110:111]
v_cvt_pk_bf16_f32 v68, v48, v49
v_cvt_pk_bf16_f32 v69, v50, v51
v_cvt_pk_bf16_f32 v70, v52, v53
v_cvt_pk_bf16_f32 v71, v54, v55
v_cvt_pk_bf16_f32 v72, v56, v57
v_cvt_pk_bf16_f32 v73, v58, v59
v_cvt_pk_bf16_f32 v74, v60, v61
v_cvt_pk_bf16_f32 v75, v62, v63
v_cvt_pk_bf16_f32 v76, v64, v65
v_cvt_pk_bf16_f32 v77, v66, v67
s_mov_b32 s42, 0x05040100
s_mov_b32 s43, 0x07060302
v_permlane32_swap_b32 v68, v69
v_permlane32_swap_b32 v70, v71
v_permlane32_swap_b32 v72, v73
v_permlane32_swap_b32 v74, v75
v_permlane32_swap_b32 v76, v77
s_nop 1
v_perm_b32 v48, v69, v68, s42
v_perm_b32 v49, v69, v68, s43
v_perm_b32 v50, v71, v70, s42
v_perm_b32 v51, v71, v70, s43
v_perm_b32 v52, v73, v72, s42
v_perm_b32 v53, v73, v72, s43
v_perm_b32 v54, v75, v74, s42
v_perm_b32 v55, v75, v74, s43
v_perm_b32 v56, v77, v76, s42
v_perm_b32 v57, v77, v76, s43
ds_write_b32 v80, v48
ds_write_b32 v81, v49
ds_write_b32 v82, v50
ds_write_b32 v83, v51
ds_write_b32 v84, v52
ds_write_b32 v85, v53
ds_write_b32 v86, v54
ds_write_b32 v87, v55
ds_write_b32 v88, v56
ds_write_b32 v89, v57
s_waitcnt lgkmcnt(0)
s_barrier
ds_read_b128 v[28:31], v95
ds_read_b128 v[32:35], v95 offset:4096
s_cmp_ge_u32 s3, 2
s_cbranch_scc1 L_ln_two
ds_read_b128 v[36:39], v95 offset:8192
s_waitcnt lgkmcnt(0)
buffer_store_dwordx4 v[36:39], v94, s[36:39], s54 offen sc1
L_ln_two:
s_waitcnt lgkmcnt(0)
buffer_store_dwordx4 v[28:31], v92, s[36:39], s54 offen sc1
buffer_store_dwordx4 v[32:35], v93, s[36:39], s54 offen sc1
buffer_load_dwordx4 v4, s[12:15], s96 offen lds
s_add_u32 m0, s46, 9216
s_nop 0
buffer_load_dwordx4 v5, s[12:15], s96 offen lds
s_add_u32 m0, s46, 10240
s_nop 0
buffer_load_dwordx4 v6, s[12:15], s96 offen lds
s_add_u32 m0, s46, 11264
s_nop 0
buffer_load_dwordx4 v7, s[12:15], s96 offen lds
s_add_u32 m0, s46, 12288
s_add_u32 s96, s96, 110592
s_cmp_eq_u32 s96, s49
s_cselect_b32 s96, s48, s96
buffer_load_dwordx4 v4, s[12:15], s96 offen lds
s_add_u32 m0, s46, 13312
s_nop 0
buffer_load_dwordx4 v5, s[12:15], s96 offen lds
s_add_u32 m0, s46, 14336
s_nop 0
buffer_load_dwordx4 v6, s[12:15], s96 offen lds
s_add_u32 m0, s46, 15360
s_nop 0
buffer_load_dwordx4 v7, s[12:15], s96 offen lds
s_add_u32 m0, s46, 16384
s_add_u32 s96, s96, 110592
s_cmp_eq_u32 s96, s49
s_cselect_b32 s96, s48, s96
s_lshl_b32 s42, s5, 7
s_lshl_b32 s43, s3, 5
s_add_u32 s42, s42, s43
v_lshrrev_b32 v12, 4, v1
v_lshlrev_b32 v12, 3, v12
buffer_load_dwordx2 v[14:15], v12, s[20:23], s42 offen
s_waitcnt vmcnt(9)
s_mov_b32 s98, 200000
L_nonce:
v_readfirstlane_b32 s40, v116
v_readfirstlane_b32 s41, v117
s_nop 3
s_sub_u32 s98, s98, 1
s_cselect_b32 s42, 1, s41
s_cmp_lg_u32 s42, 0
s_cbranch_scc1 L_nonce_ok
buffer_load_dwordx2 v[116:117], v118, s[32:35], 0 offen sc1
s_waitcnt vmcnt(0)
s_branch L_nonce
L_nonce_ok:
s_barrier
s_lshl_b32 s44, s2, 5
s_add_u32 s44, s44, 5242880
s_cmp_lg_u32 s3, 0
s_cbranch_scc1 L_flag_ln
v_mov_b32 v16, s40
v_mov_b32 v17, s41
v_mov_b32 v18, 0
s_mov_b64 s[100:101], exec
s_mov_b64 exec, 1
buffer_store_dwordx2 v[16:17], v18, s[36:39], s44 offen sc1
s_mov_b64 exec, s[100:101]
s_nop 1
L_flag_ln:
s_cmp_eq_u32 s7, 0
s_cbranch_scc1 L_idle
s_mov_b32 s42, s94
s_and_b32 s42, s42, 3
s_mul_i32 s42, s42, 16
s_lshr_b32 s52, s42, 2
s_lshl_b32 s42, s94, 6
s_lshl_b32 s43, s3, 4
s_add_u32 s42, s42, s43
s_mul_i32 s50, s42, 5120
s_add_u32 s51, s50, 81920
s_mul_i32 s97, s52, 5120
s_add_u32 s97, s97, s50
s_lshl_b32 s44, s3, 11
s_add_u32 s54, s44, 5242880
v_lshlrev_b32 v122, 5, v1
buffer_load_dwordx4 v4, s[12:15], s96 offen lds
s_add_u32 m0, s46, 17408
s_nop 0
buffer_load_dwordx4 v5, s[12:15], s96 offen lds
s_add_u32 m0, s46, 18432
s_nop 0
buffer_load_dwordx4 v6, s[12:15], s96 offen lds
s_add_u32 m0, s46, 19456
s_nop 0
buffer_load_dwordx4 v7, s[12:15], s96 offen lds
s_add_u32 m0, s46, 20480
s_add_u32 s96, s96, 110592
s_cmp_eq_u32 s96, s49
s_cselect_b32 s96, s48, s96
buffer_load_dwordx4 v4, s[12:15], s96 offen lds
s_add_u32 m0, s46, 21504
s_nop 0
buffer_load_dwordx4 v5, s[12:15], s96 offen lds
s_add_u32 m0, s46, 22528
s_nop 0
buffer_load_dwordx4 v6, s[12:15], s96 offen lds
s_add_u32 m0, s46, 23552
s_nop 0
buffer_load_dwordx4 v7, s[12:15], s96 offen lds
s_add_u32 m0, s46, 24576
s_add_u32 s96, s96, 110592
s_cmp_eq_u32 s96, s49
s_cselect_b32 s96, s48, s96
buffer_load_dwordx4 v4, s[12:15], s96 offen lds
s_add_u32 m0, s46, 25600
s_nop 0
buffer_load_dwordx4 v5, s[12:15], s96 offen lds
s_add_u32 m0, s46, 26624
s_nop 0
buffer_load_dwordx4 v6, s[12:15], s96 offen lds
s_add_u32 m0, s46, 27648
s_nop 0
buffer_load_dwordx4 v7, s[12:15], s96 offen lds
s_add_u32 m0, s46, 28672
s_add_u32 s96, s96, 110592
s_cmp_eq_u32 s96, s49
s_cselect_b32 s96, s48, s96
buffer_load_dwordx4 v4, s[12:15], s96 offen lds
s_add_u32 m0, s46, 29696
s_nop 0
buffer_load_dwordx4 v5, s[12:15], s96 offen lds
s_add_u32 m0, s46, 30720
s_nop 0
buffer_load_dwordx4 v6, s[12:15], s96 offen lds
s_add_u32 m0, s46, 31744
s_nop 0
buffer_load_dwordx4 v7, s[12:15], s96 offen lds
s_add_u32 m0, s46, 32768
s_add_u32 s96, s96, 110592
s_cmp_eq_u32 s96, s49
s_cselect_b32 s96, s48, s96
buffer_load_dwordx4 v4, s[12:15], s96 offen lds
s_add_u32 m0, s46, 33792
s_nop 0
buffer_load_dwordx4 v5, s[12:15], s96 offen lds
s_add_u32 m0, s46, 34816
s_nop 0
buffer_load_dwordx4 v6, s[12:15], s96 offen lds
s_add_u32 m0, s46, 35840
s_nop 0
buffer_load_dwordx4 v7, s[12:15], s96 offen lds
s_add_u32 m0, s46, 0
s_add_u32 s96, s96, 110592
s_cmp_eq_u32 s96, s49
s_cselect_b32 s96, s48, s96
ds_read_b64_tr_b16 a[0:1], v8 offset:0
ds_read_b64_tr_b16 a[2:3], v8 offset:512
ds_read_b64_tr_b16 a[4:5], v9 offset:0
ds_read_b64_tr_b16 a[6:7], v9 offset:512
ds_read_b64_tr_b16 a[8:9], v10 offset:0
ds_read_b64_tr_b16 a[10:11], v10 offset:512
ds_read_b64_tr_b16 a[12:13], v11 offset:0
ds_read_b64_tr_b16 a[14:15], v11 offset:512
ds_read_b64_tr_b16 a[16:17], v8 offset:4096
ds_read_b64_tr_b16 a[18:19], v8 offset:4608
ds_read_b64_tr_b16 a[20:21], v9 offset:4096
ds_read_b64_tr_b16 a[22:23], v9 offset:4608
ds_read_b64_tr_b16 a[24:25], v10 offset:4096
ds_read_b64_tr_b16 a[26:27], v10 offset:4608
ds_read_b64_tr_b16 a[28:29], v11 offset:4096
ds_read_b64_tr_b16 a[30:31], v11 offset:4608
s_waitcnt lgkmcnt(8)
buffer_load_dwordx4 v4, s[12:15], s96 offen lds
s_add_u32 m0, s46, 1024
s_nop 0
buffer_load_dwordx4 v5, s[12:15], s96 offen lds
s_add_u32 m0, s46, 2048
s_nop 0
buffer_load_dwordx4 v6, s[12:15], s96 offen lds
s_add_u32 m0, s46, 3072
s_nop 0
buffer_load_dwordx4 v7, s[12:15], s96 offen lds
s_add_u32 m0, s46, 4096
s_add_u32 s96, s96, 110592
s_cmp_eq_u32 s96, s49
s_cselect_b32 s96, s48, s96
s_waitcnt vmcnt(29)
ds_read_b64_tr_b16 a[32:33], v8 offset:8192
ds_read_b64_tr_b16 a[34:35], v8 offset:8704
ds_read_b64_tr_b16 a[36:37], v9 offset:8192
ds_read_b64_tr_b16 a[38:39], v9 offset:8704
ds_read_b64_tr_b16 a[40:41], v10 offset:8192
ds_read_b64_tr_b16 a[42:43], v10 offset:8704
ds_read_b64_tr_b16 a[44:45], v11 offset:8192
ds_read_b64_tr_b16 a[46:47], v11 offset:8704
s_waitcnt lgkmcnt(8)
buffer_load_dwordx4 v4, s[12:15], s96 offen lds
s_add_u32 m0, s46, 5120
s_nop 0
buffer_load_dwordx4 v5, s[12:15], s96 offen lds
s_add_u32 m0, s46, 6144
s_nop 0
buffer_load_dwordx4 v6, s[12:15], s96 offen lds
s_add_u32 m0, s46, 7168
s_nop 0
buffer_load_dwordx4 v7, s[12:15], s96 offen lds
s_add_u32 m0, s46, 8192
s_add_u32 s96, s96, 110592
s_cmp_eq_u32 s96, s49
s_cselect_b32 s96, s48, s96
s_waitcnt lgkmcnt(0)
buffer_load_dwordx4 v4, s[12:15], s96 offen lds
s_add_u32 m0, s46, 9216
s_nop 0
buffer_load_dwordx4 v5, s[12:15], s96 offen lds
s_add_u32 m0, s46, 10240
s_nop 0
buffer_load_dwordx4 v6, s[12:15], s96 offen lds
s_add_u32 m0, s46, 11264
s_nop 0
buffer_load_dwordx4 v7, s[12:15], s96 offen lds
s_add_u32 m0, s46, 12288
s_add_u32 s96, s96, 110592
s_cmp_eq_u32 s96, s49
s_cselect_b32 s96, s48, s96
buffer_load_dwordx2 v[120:121], v122, s[36:39], s54 offen sc1
s_waitcnt vmcnt(34)
ds_read_b64_tr_b16 a[48:49], v8 offset:12288
ds_read_b64_tr_b16 a[50:51], v8 offset:12800
ds_read_b64_tr_b16 a[52:53], v9 offset:12288
ds_read_b64_tr_b16 a[54:55], v9 offset:12800
ds_read_b64_tr_b16 a[56:57], v10 offset:12288
ds_read_b64_tr_b16 a[58:59], v10 offset:12800
ds_read_b64_tr_b16 a[60:61], v11 offset:12288
ds_read_b64_tr_b16 a[62:63], v11 offset:12800
s_waitcnt vmcnt(29)
ds_read_b64_tr_b16 a[64:65], v8 offset:16384
ds_read_b64_tr_b16 a[66:67], v8 offset:16896
ds_read_b64_tr_b16 a[68:69], v9 offset:16384
ds_read_b64_tr_b16 a[70:71], v9 offset:16896
ds_read_b64_tr_b16 a[72:73], v10 offset:16384
ds_read_b64_tr_b16 a[74:75], v10 offset:16896
ds_read_b64_tr_b16 a[76:77], v11 offset:16384
ds_read_b64_tr_b16 a[78:79], v11 offset:16896
s_waitcnt lgkmcnt(8)
buffer_load_dwordx4 v4, s[12:15], s96 offen lds
s_add_u32 m0, s46, 13312
s_nop 0
buffer_load_dwordx4 v5, s[12:15], s96 offen lds
s_add_u32 m0, s46, 14336
s_nop 0
buffer_load_dwordx4 v6, s[12:15], s96 offen lds
s_add_u32 m0, s46, 15360
s_nop 0
buffer_load_dwordx4 v7, s[12:15], s96 offen lds
s_add_u32 m0, s46, 16384
s_add_u32 s96, s96, 110592
s_cmp_eq_u32 s96, s49
s_cselect_b32 s96, s48, s96
s_waitcnt lgkmcnt(0)
buffer_load_dwordx4 v4, s[12:15], s96 offen lds
s_add_u32 m0, s46, 17408
s_nop 0
buffer_load_dwordx4 v5, s[12:15], s96 offen lds
s_add_u32 m0, s46, 18432
s_nop 0
buffer_load_dwordx4 v6, s[12:15], s96 offen lds
s_add_u32 m0, s46, 19456
s_nop 0
buffer_load_dwordx4 v7, s[12:15], s96 offen lds
s_add_u32 m0, s46, 20480
s_add_u32 s96, s96, 110592
s_cmp_eq_u32 s96, s49
s_cselect_b32 s96, s48, s96
s_waitcnt vmcnt(8)
s_mov_b32 s98, 200000
L_poll_ln:
v_cmp_ne_u32 vcc, s40, v120
v_cmp_ne_u32 s[42:43], s41, v121
s_nop 3
s_or_b64 vcc, vcc, s[42:43]
s_cbranch_vccz L_poll_ln_ok
s_sleep 1
buffer_load_dwordx2 v[120:121], v122, s[36:39], s54 offen sc1
s_waitcnt vmcnt(0)
s_sub_u32 s98, s98, 1
s_cbranch_scc0 L_poll_ln
L_poll_ln_ok:
buffer_load_dwordx4 v[16:19], v2, s[36:39], s97 offen offset:0 sc1
buffer_load_dwordx4 v[20:23], v2, s[36:39], s97 offen offset:1024 sc1
buffer_load_dwordx4 v[24:27], v2, s[36:39], s97 offen offset:2048 sc1
buffer_load_dwordx4 v[28:31], v2, s[36:39], s97 offen offset:3072 sc1
buffer_load_dwordx4 v[32:35], v3, s[36:39], s97 offen sc1
s_add_u32 s97, s97, 5120
s_cmp_eq_u32 s97, s51
s_cselect_b32 s97, s50, s97
buffer_load_dwordx4 v[36:39], v2, s[36:39], s97 offen offset:0 sc1
buffer_load_dwordx4 v[40:43], v2, s[36:39], s97 offen offset:1024 sc1
buffer_load_dwordx4 v[44:47], v2, s[36:39], s97 offen offset:2048 sc1
buffer_load_dwordx4 v[48:51], v2, s[36:39], s97 offen offset:3072 sc1
buffer_load_dwordx4 v[52:55], v3, s[36:39], s97 offen sc1
s_add_u32 s97, s97, 5120
s_cmp_eq_u32 s97, s51
s_cselect_b32 s97, s50, s97
buffer_load_dwordx4 v[56:59], v2, s[36:39], s97 offen offset:0 sc1
buffer_load_dwordx4 v[60:63], v2, s[36:39], s97 offen offset:1024 sc1
buffer_load_dwordx4 v[64:67], v2, s[36:39], s97 offen offset:2048 sc1
buffer_load_dwordx4 v[68:71], v2, s[36:39], s97 offen offset:3072 sc1
buffer_load_dwordx4 v[72:75], v3, s[36:39], s97 offen sc1
s_add_u32 s97, s97, 5120
s_cmp_eq_u32 s97, s51
s_cselect_b32 s97, s50, s97
buffer_load_dwordx4 v[76:79], v2, s[36:39], s97 offen offset:0 sc1
buffer_load_dwordx4 v[80:83], v2, s[36:39], s97 offen offset:1024 sc1
buffer_load_dwordx4 v[84:87], v2, s[36:39], s97 offen offset:2048 sc1
buffer_load_dwordx4 v[88:91], v2, s[36:39], s97 offen offset:3072 sc1
buffer_load_dwordx4 v[92:95], v3, s[36:39], s97 offen sc1
s_add_u32 s97, s97, 5120
s_cmp_eq_u32 s97, s51
s_cselect_b32 s97, s50, s97
v_lshlrev_b32 v160, 16, v14
v_and_b32 v161, 0xffff0000, v14
v_lshlrev_b32 v162, 16, v15
v_and_b32 v163, 0xffff0000, v15
s_waitcnt vmcnt(15)
s_waitcnt lgkmcnt(0)
v_mfma_f32_16x16x32_bf16 v[176:179], a[0:3], v[16:19], v[160:163]
v_mfma_f32_16x16x32_bf16 v[196:199], a[4:7], v[16:19], 0
v_mfma_f32_16x16x32_bf16 v[216:219], a[8:11], v[16:19], 0
v_mfma_f32_16x16x32_bf16 v[236:239], a[12:15], v[16:19], 0
s_add_u32 s42, s3, 1
buffer_load_dwordx4 v[16:19], v2, s[36:39], s97 offen offset:0 sc1
v_mfma_f32_16x16x32_bf16 v[180:183], a[0:3], v[20:23], v[160:163]
v_mfma_f32_16x16x32_bf16 v[200:203], a[4:7], v[20:23], 0
v_mfma_f32_16x16x32_bf16 v[220:223], a[8:11], v[20:23], 0
v_mfma_f32_16x16x32_bf16 v[240:243], a[12:15], v[20:23], 0
s_and_b32 s42, s42, 3
buffer_load_dwordx4 v[20:23], v2, s[36:39], s97 offen offset:1024 sc1
v_mfma_f32_16x16x32_bf16 v[184:187], a[0:3], v[24:27], v[160:163]
v_mfma_f32_16x16x32_bf16 v[204:207], a[4:7], v[24:27], 0
v_mfma_f32_16x16x32_bf16 v[224:227], a[8:11], v[24:27], 0
v_mfma_f32_16x16x32_bf16 v[244:247], a[12:15], v[24:27], 0
s_mul_i32 s43, s42, 36864
buffer_load_dwordx4 v[24:27], v2, s[36:39], s97 offen offset:2048 sc1
v_mfma_f32_16x16x32_bf16 v[188:191], a[0:3], v[28:31], v[160:163]
v_mfma_f32_16x16x32_bf16 v[208:211], a[4:7], v[28:31], 0
v_mfma_f32_16x16x32_bf16 v[228:231], a[8:11], v[28:31], 0
v_mfma_f32_16x16x32_bf16 v[248:251], a[12:15], v[28:31], 0
s_add_u32 s43, s43, 24576
buffer_load_dwordx4 v[28:31], v2, s[36:39], s97 offen offset:3072 sc1
v_mfma_f32_16x16x32_bf16 v[192:195], a[0:3], v[32:35], v[160:163]
v_mfma_f32_16x16x32_bf16 v[212:215], a[4:7], v[32:35], 0
v_mfma_f32_16x16x32_bf16 v[232:235], a[8:11], v[32:35], 0
v_mfma_f32_16x16x32_bf16 v[252:255], a[12:15], v[32:35], 0
v_add_u32 v137, s43, v2
buffer_load_dwordx4 v[32:35], v3, s[36:39], s97 offen sc1
s_add_u32 s97, s97, 5120
s_cmp_eq_u32 s97, s51
s_cselect_b32 s97, s50, s97
s_waitcnt vmcnt(15)
v_mfma_f32_16x16x32_bf16 v[176:179], a[16:19], v[36:39], v[176:179]
v_mfma_f32_16x16x32_bf16 v[196:199], a[20:23], v[36:39], v[196:199]
v_mfma_f32_16x16x32_bf16 v[216:219], a[24:27], v[36:39], v[216:219]
v_mfma_f32_16x16x32_bf16 v[236:239], a[28:31], v[36:39], v[236:239]
s_add_u32 s42, s3, 2
buffer_load_dwordx4 v[36:39], v2, s[36:39], s97 offen offset:0 sc1
v_mfma_f32_16x16x32_bf16 v[180:183], a[16:19], v[40:43], v[180:183]
v_mfma_f32_16x16x32_bf16 v[200:203], a[20:23], v[40:43], v[200:203]
v_mfma_f32_16x16x32_bf16 v[220:223], a[24:27], v[40:43], v[220:223]
v_mfma_f32_16x16x32_bf16 v[240:243], a[28:31], v[40:43], v[240:243]
s_and_b32 s42, s42, 3
buffer_load_dwordx4 v[40:43], v2, s[36:39], s97 offen offset:1024 sc1
v_mfma_f32_16x16x32_bf16 v[184:187], a[16:19], v[44:47], v[184:187]
v_mfma_f32_16x16x32_bf16 v[204:207], a[20:23], v[44:47], v[204:207]
v_mfma_f32_16x16x32_bf16 v[224:227], a[24:27], v[44:47], v[224:227]
v_mfma_f32_16x16x32_bf16 v[244:247], a[28:31], v[44:47], v[244:247]
s_mul_i32 s43, s42, 36864
buffer_load_dwordx4 v[44:47], v2, s[36:39], s97 offen offset:2048 sc1
v_mfma_f32_16x16x32_bf16 v[188:191], a[16:19], v[48:51], v[188:191]
v_mfma_f32_16x16x32_bf16 v[208:211], a[20:23], v[48:51], v[208:211]
v_mfma_f32_16x16x32_bf16 v[228:231], a[24:27], v[48:51], v[228:231]
v_mfma_f32_16x16x32_bf16 v[248:251], a[28:31], v[48:51], v[248:251]
s_add_u32 s43, s43, 24576
buffer_load_dwordx4 v[48:51], v2, s[36:39], s97 offen offset:3072 sc1
v_mfma_f32_16x16x32_bf16 v[192:195], a[16:19], v[52:55], v[192:195]
v_mfma_f32_16x16x32_bf16 v[212:215], a[20:23], v[52:55], v[212:215]
v_mfma_f32_16x16x32_bf16 v[232:235], a[24:27], v[52:55], v[232:235]
v_mfma_f32_16x16x32_bf16 v[252:255], a[28:31], v[52:55], v[252:255]
v_add_u32 v138, s43, v2
buffer_load_dwordx4 v[52:55], v3, s[36:39], s97 offen sc1
s_add_u32 s97, s97, 5120
s_cmp_eq_u32 s97, s51
s_cselect_b32 s97, s50, s97
s_waitcnt vmcnt(15)
v_mfma_f32_16x16x32_bf16 v[176:179], a[32:35], v[56:59], v[176:179]
v_mfma_f32_16x16x32_bf16 v[196:199], a[36:39], v[56:59], v[196:199]
v_mfma_f32_16x16x32_bf16 v[216:219], a[40:43], v[56:59], v[216:219]
v_mfma_f32_16x16x32_bf16 v[236:239], a[44:47], v[56:59], v[236:239]
s_add_u32 s42, s3, 3
buffer_load_dwordx4 v[56:59], v2, s[36:39], s97 offen offset:0 sc1
v_mfma_f32_16x16x32_bf16 v[180:183], a[32:35], v[60:63], v[180:183]
v_mfma_f32_16x16x32_bf16 v[200:203], a[36:39], v[60:63], v[200:203]
v_mfma_f32_16x16x32_bf16 v[220:223], a[40:43], v[60:63], v[220:223]
v_mfma_f32_16x16x32_bf16 v[240:243], a[44:47], v[60:63], v[240:243]
s_and_b32 s42, s42, 3
buffer_load_dwordx4 v[60:63], v2, s[36:39], s97 offen offset:1024 sc1
v_mfma_f32_16x16x32_bf16 v[184:187], a[32:35], v[64:67], v[184:187]
v_mfma_f32_16x16x32_bf16 v[204:207], a[36:39], v[64:67], v[204:207]
v_mfma_f32_16x16x32_bf16 v[224:227], a[40:43], v[64:67], v[224:227]
v_mfma_f32_16x16x32_bf16 v[244:247], a[44:47], v[64:67], v[244:247]
s_mul_i32 s43, s42, 36864
buffer_load_dwordx4 v[64:67], v2, s[36:39], s97 offen offset:2048 sc1
v_mfma_f32_16x16x32_bf16 v[188:191], a[32:35], v[68:71], v[188:191]
v_mfma_f32_16x16x32_bf16 v[208:211], a[36:39], v[68:71], v[208:211]
v_mfma_f32_16x16x32_bf16 v[228:231], a[40:43], v[68:71], v[228:231]
v_mfma_f32_16x16x32_bf16 v[248:251], a[44:47], v[68:71], v[248:251]
s_add_u32 s43, s43, 24576
buffer_load_dwordx4 v[68:71], v2, s[36:39], s97 offen offset:3072 sc1
v_mfma_f32_16x16x32_bf16 v[192:195], a[32:35], v[72:75], v[192:195]
v_mfma_f32_16x16x32_bf16 v[212:215], a[36:39], v[72:75], v[212:215]
v_mfma_f32_16x16x32_bf16 v[232:235], a[40:43], v[72:75], v[232:235]
v_mfma_f32_16x16x32_bf16 v[252:255], a[44:47], v[72:75], v[252:255]
v_add_u32 v139, s43, v2
buffer_load_dwordx4 v[72:75], v3, s[36:39], s97 offen sc1
s_add_u32 s97, s97, 5120
s_cmp_eq_u32 s97, s51
s_cselect_b32 s97, s50, s97
s_waitcnt vmcnt(15)
v_mfma_f32_16x16x32_bf16 v[176:179], a[48:51], v[76:79], v[176:179]
v_mfma_f32_16x16x32_bf16 v[196:199], a[52:55], v[76:79], v[196:199]
v_mfma_f32_16x16x32_bf16 v[216:219], a[56:59], v[76:79], v[216:219]
v_mfma_f32_16x16x32_bf16 v[236:239], a[60:63], v[76:79], v[236:239]
s_mul_i32 s43, s42, 3072
buffer_load_dwordx4 v[76:79], v2, s[36:39], s97 offen offset:0 sc1
v_mfma_f32_16x16x32_bf16 v[180:183], a[48:51], v[80:83], v[180:183]
v_mfma_f32_16x16x32_bf16 v[200:203], a[52:55], v[80:83], v[200:203]
v_mfma_f32_16x16x32_bf16 v[220:223], a[56:59], v[80:83], v[220:223]
v_mfma_f32_16x16x32_bf16 v[240:243], a[60:63], v[80:83], v[240:243]
s_add_u32 s43, s43, 147456
buffer_load_dwordx4 v[80:83], v2, s[36:39], s97 offen offset:1024 sc1
v_mfma_f32_16x16x32_bf16 v[184:187], a[48:51], v[84:87], v[184:187]
v_mfma_f32_16x16x32_bf16 v[204:207], a[52:55], v[84:87], v[204:207]
v_mfma_f32_16x16x32_bf16 v[224:227], a[56:59], v[84:87], v[224:227]
v_mfma_f32_16x16x32_bf16 v[244:247], a[60:63], v[84:87], v[244:247]
v_add_u32 v140, s43, v2
buffer_load_dwordx4 v[84:87], v2, s[36:39], s97 offen offset:2048 sc1
v_mfma_f32_16x16x32_bf16 v[188:191], a[48:51], v[88:91], v[188:191]
v_mfma_f32_16x16x32_bf16 v[208:211], a[52:55], v[88:91], v[208:211]
v_mfma_f32_16x16x32_bf16 v[228:231], a[56:59], v[88:91], v[228:231]
v_mfma_f32_16x16x32_bf16 v[248:251], a[60:63], v[88:91], v[248:251]
s_add_u32 s43, s46, 24576
buffer_load_dwordx4 v[88:91], v2, s[36:39], s97 offen offset:3072 sc1
v_mfma_f32_16x16x32_bf16 v[192:195], a[48:51], v[92:95], v[192:195]
v_mfma_f32_16x16x32_bf16 v[212:215], a[52:55], v[92:95], v[212:215]
v_mfma_f32_16x16x32_bf16 v[232:235], a[56:59], v[92:95], v[232:235]
v_mfma_f32_16x16x32_bf16 v[252:255], a[60:63], v[92:95], v[252:255]
v_add_u32 v141, s43, v2
buffer_load_dwordx4 v[92:95], v3, s[36:39], s97 offen sc1
s_add_u32 s97, s97, 5120
s_cmp_eq_u32 s97, s51
s_cselect_b32 s97, s50, s97
s_waitcnt vmcnt(15)
v_mfma_f32_16x16x32_bf16 v[176:179], a[64:67], v[16:19], v[176:179]
ds_read_b64_tr_b16 a[80:81], v8 offset:20480
v_mfma_f32_16x16x32_bf16 v[196:199], a[68:71], v[16:19], v[196:199]
ds_read_b64_tr_b16 a[82:83], v8 offset:20992
v_mfma_f32_16x16x32_bf16 v[216:219], a[72:75], v[16:19], v[216:219]
ds_read_b64_tr_b16 a[84:85], v9 offset:20480
v_mfma_f32_16x16x32_bf16 v[236:239], a[76:79], v[16:19], v[236:239]
ds_read_b64_tr_b16 a[86:87], v9 offset:20992
buffer_load_dwordx4 v[16:19], v2, s[36:39], s97 offen offset:0 sc1
v_mfma_f32_16x16x32_bf16 v[180:183], a[64:67], v[20:23], v[180:183]
ds_read_b64_tr_b16 a[88:89], v10 offset:20480
v_mfma_f32_16x16x32_bf16 v[200:203], a[68:71], v[20:23], v[200:203]
ds_read_b64_tr_b16 a[90:91], v10 offset:20992
v_mfma_f32_16x16x32_bf16 v[220:223], a[72:75], v[20:23], v[220:223]
ds_read_b64_tr_b16 a[92:93], v11 offset:20480
v_mfma_f32_16x16x32_bf16 v[240:243], a[76:79], v[20:23], v[240:243]
ds_read_b64_tr_b16 a[94:95], v11 offset:20992
buffer_load_dwordx4 v[20:23], v2, s[36:39], s97 offen offset:1024 sc1
v_mfma_f32_16x16x32_bf16 v[184:187], a[64:67], v[24:27], v[184:187]
v_mfma_f32_16x16x32_bf16 v[204:207], a[68:71], v[24:27], v[204:207]
v_mfma_f32_16x16x32_bf16 v[224:227], a[72:75], v[24:27], v[224:227]
v_mfma_f32_16x16x32_bf16 v[244:247], a[76:79], v[24:27], v[244:247]
s_mul_i32 s43, s3, 3072
buffer_load_dwordx4 v[24:27], v2, s[36:39], s97 offen offset:2048 sc1
v_mfma_f32_16x16x32_bf16 v[188:191], a[64:67], v[28:31], v[188:191]
v_mfma_f32_16x16x32_bf16 v[208:211], a[68:71], v[28:31], v[208:211]
v_mfma_f32_16x16x32_bf16 v[228:231], a[72:75], v[28:31], v[228:231]
v_mfma_f32_16x16x32_bf16 v[248:251], a[76:79], v[28:31], v[248:251]
s_add_u32 s43, s43, 147456
buffer_load_dwordx4 v[28:31], v2, s[36:39], s97 offen offset:3072 sc1
v_mfma_f32_16x16x32_bf16 v[192:195], a[64:67], v[32:35], v[192:195]
v_mfma_f32_16x16x32_bf16 v[212:215], a[68:71], v[32:35], v[212:215]
v_mfma_f32_16x16x32_bf16 v[232:235], a[72:75], v[32:35], v[232:235]
v_mfma_f32_16x16x32_bf16 v[252:255], a[76:79], v[32:35], v[252:255]
v_add_u32 v142, s43, v2
buffer_load_dwordx4 v[32:35], v3, s[36:39], s97 offen sc1
s_add_u32 s97, s97, 5120
s_cmp_eq_u32 s97, s51
s_cselect_b32 s97, s50, s97
s_waitcnt vmcnt(15)
s_waitcnt lgkmcnt(0)
v_mfma_f32_16x16x32_bf16 v[176:179], a[80:83], v[36:39], v[176:179]
ds_read_b64_tr_b16 a[96:97], v8 offset:24576
v_mfma_f32_16x16x32_bf16 v[196:199], a[84:87], v[36:39], v[196:199]
ds_read_b64_tr_b16 a[98:99], v8 offset:25088
buffer_load_dwordx4 v4, s[12:15], s96 offen lds
s_add_u32 m0, s46, 21504
v_mfma_f32_16x16x32_bf16 v[216:219], a[88:91], v[36:39], v[216:219]
ds_read_b64_tr_b16 a[100:101], v9 offset:24576
v_mfma_f32_16x16x32_bf16 v[236:239], a[92:95], v[36:39], v[236:239]
ds_read_b64_tr_b16 a[102:103], v9 offset:25088
buffer_load_dwordx4 v[36:39], v2, s[36:39], s97 offen offset:0 sc1
v_mfma_f32_16x16x32_bf16 v[180:183], a[80:83], v[40:43], v[180:183]
ds_read_b64_tr_b16 a[104:105], v10 offset:24576
v_mfma_f32_16x16x32_bf16 v[200:203], a[84:87], v[40:43], v[200:203]
ds_read_b64_tr_b16 a[106:107], v10 offset:25088
buffer_load_dwordx4 v5, s[12:15], s96 offen lds
s_add_u32 m0, s46, 22528
v_mfma_f32_16x16x32_bf16 v[220:223], a[88:91], v[40:43], v[220:223]
ds_read_b64_tr_b16 a[108:109], v11 offset:24576
v_mfma_f32_16x16x32_bf16 v[240:243], a[92:95], v[40:43], v[240:243]
ds_read_b64_tr_b16 a[110:111], v11 offset:25088
buffer_load_dwordx4 v[40:43], v2, s[36:39], s97 offen offset:1024 sc1
v_mfma_f32_16x16x32_bf16 v[184:187], a[80:83], v[44:47], v[184:187]
v_mfma_f32_16x16x32_bf16 v[204:207], a[84:87], v[44:47], v[204:207]
buffer_load_dwordx4 v6, s[12:15], s96 offen lds
s_add_u32 m0, s46, 23552
v_mfma_f32_16x16x32_bf16 v[224:227], a[88:91], v[44:47], v[224:227]
v_mfma_f32_16x16x32_bf16 v[244:247], a[92:95], v[44:47], v[244:247]
v_lshrrev_b32 v12, 4, v1
buffer_load_dwordx4 v[44:47], v2, s[36:39], s97 offen offset:2048 sc1
v_mfma_f32_16x16x32_bf16 v[188:191], a[80:83], v[48:51], v[188:191]
v_mfma_f32_16x16x32_bf16 v[208:211], a[84:87], v[48:51], v[208:211]
buffer_load_dwordx4 v7, s[12:15], s96 offen lds
s_add_u32 m0, s46, 24576
s_add_u32 s96, s96, 110592
s_cmp_eq_u32 s96, s49
s_cselect_b32 s96, s48, s96
v_mfma_f32_16x16x32_bf16 v[228:231], a[88:91], v[48:51], v[228:231]
v_mfma_f32_16x16x32_bf16 v[248:251], a[92:95], v[48:51], v[248:251]
v_and_b32 v13, 1, v12
buffer_load_dwordx4 v[48:51], v2, s[36:39], s97 offen offset:3072 sc1
v_mfma_f32_16x16x32_bf16 v[192:195], a[80:83], v[52:55], v[192:195]
v_mfma_f32_16x16x32_bf16 v[212:215], a[84:87], v[52:55], v[212:215]
v_mfma_f32_16x16x32_bf16 v[232:235], a[88:91], v[52:55], v[232:235]
v_mfma_f32_16x16x32_bf16 v[252:255], a[92:95], v[52:55], v[252:255]
v_lshlrev_b32 v133, 10, v13
buffer_load_dwordx4 v[52:55], v3, s[36:39], s97 offen sc1
s_add_u32 s97, s97, 5120
s_cmp_eq_u32 s97, s51
s_cselect_b32 s97, s50, s97
s_waitcnt vmcnt(19)
s_waitcnt lgkmcnt(0)
v_mfma_f32_16x16x32_bf16 v[176:179], a[96:99], v[56:59], v[176:179]
ds_read_b64_tr_b16 a[112:113], v8 offset:28672
v_mfma_f32_16x16x32_bf16 v[196:199], a[100:103], v[56:59], v[196:199]
ds_read_b64_tr_b16 a[114:115], v8 offset:29184
buffer_load_dwordx4 v4, s[12:15], s96 offen lds
s_add_u32 m0, s46, 25600
v_mfma_f32_16x16x32_bf16 v[216:219], a[104:107], v[56:59], v[216:219]
ds_read_b64_tr_b16 a[116:117], v9 offset:28672
v_mfma_f32_16x16x32_bf16 v[236:239], a[108:111], v[56:59], v[236:239]
ds_read_b64_tr_b16 a[118:119], v9 offset:29184
buffer_load_dwordx4 v[56:59], v2, s[36:39], s97 offen offset:0 sc1
v_mfma_f32_16x16x32_bf16 v[180:183], a[96:99], v[60:63], v[180:183]
ds_read_b64_tr_b16 a[120:121], v10 offset:28672
v_mfma_f32_16x16x32_bf16 v[200:203], a[100:103], v[60:63], v[200:203]
ds_read_b64_tr_b16 a[122:123], v10 offset:29184
buffer_load_dwordx4 v5, s[12:15], s96 offen lds
s_add_u32 m0, s46, 26624
v_mfma_f32_16x16x32_bf16 v[220:223], a[104:107], v[60:63], v[220:223]
ds_read_b64_tr_b16 a[124:125], v11 offset:28672
v_mfma_f32_16x16x32_bf16 v[240:243], a[108:111], v[60:63], v[240:243]
ds_read_b64_tr_b16 a[126:127], v11 offset:29184
buffer_load_dwordx4 v[60:63], v2, s[36:39], s97 offen offset:1024 sc1
v_mfma_f32_16x16x32_bf16 v[184:187], a[96:99], v[64:67], v[184:187]
v_mfma_f32_16x16x32_bf16 v[204:207], a[100:103], v[64:67], v[204:207]
buffer_load_dwordx4 v6, s[12:15], s96 offen lds
s_add_u32 m0, s46, 27648
v_mfma_f32_16x16x32_bf16 v[224:227], a[104:107], v[64:67], v[224:227]
v_mfma_f32_16x16x32_bf16 v[244:247], a[108:111], v[64:67], v[244:247]
v_lshlrev_b32 v135, 5, v13
buffer_load_dwordx4 v[64:67], v2, s[36:39], s97 offen offset:2048 sc1
v_mfma_f32_16x16x32_bf16 v[188:191], a[96:99], v[68:71], v[188:191]
v_mfma_f32_16x16x32_bf16 v[208:211], a[100:103], v[68:71], v[208:211]
buffer_load_dwordx4 v7, s[12:15], s96 offen lds
s_add_u32 s96, s96, 110592
s_cmp_eq_u32 s96, s49
s_cselect_b32 s96, s48, s96
v_mfma_f32_16x16x32_bf16 v[228:231], a[104:107], v[68:71], v[228:231]
v_mfma_f32_16x16x32_bf16 v[248:251], a[108:111], v[68:71], v[248:251]
v_lshrrev_b32 v12, 1, v12
buffer_load_dwordx4 v[68:71], v2, s[36:39], s97 offen offset:3072 sc1
v_mfma_f32_16x16x32_bf16 v[192:195], a[96:99], v[72:75], v[192:195]
v_mfma_f32_16x16x32_bf16 v[212:215], a[100:103], v[72:75], v[212:215]
v_mfma_f32_16x16x32_bf16 v[232:235], a[104:107], v[72:75], v[232:235]
v_mfma_f32_16x16x32_bf16 v[252:255], a[108:111], v[72:75], v[252:255]
v_lshl_add_u32 v134, v12, 8, 0
buffer_load_dwordx4 v[72:75], v3, s[36:39], s97 offen sc1
s_add_u32 s97, s97, 5120
s_cmp_eq_u32 s97, s51
s_cselect_b32 s97, s50, s97
s_waitcnt vmcnt(23)
s_waitcnt lgkmcnt(0)
v_mfma_f32_16x16x32_bf16 v[176:179], a[112:115], v[76:79], v[176:179]
ds_read_b64_tr_b16 a[128:129], v8 offset:32768
v_mfma_f32_16x16x32_bf16 v[196:199], a[116:119], v[76:79], v[196:199]
ds_read_b64_tr_b16 a[130:131], v8 offset:33280
v_mfma_f32_16x16x32_bf16 v[216:219], a[120:123], v[76:79], v[216:219]
ds_read_b64_tr_b16 a[132:133], v9 offset:32768
v_mfma_f32_16x16x32_bf16 v[236:239], a[124:127], v[76:79], v[236:239]
ds_read_b64_tr_b16 a[134:135], v9 offset:33280
buffer_load_dwordx4 v[76:79], v2, s[36:39], s97 offen offset:0 sc1
v_mfma_f32_16x16x32_bf16 v[180:183], a[112:115], v[80:83], v[180:183]
ds_read_b64_tr_b16 a[136:137], v10 offset:32768
v_mfma_f32_16x16x32_bf16 v[200:203], a[116:119], v[80:83], v[200:203]
ds_read_b64_tr_b16 a[138:139], v10 offset:33280
v_mfma_f32_16x16x32_bf16 v[220:223], a[120:123], v[80:83], v[220:223]
ds_read_b64_tr_b16 a[140:141], v11 offset:32768
v_mfma_f32_16x16x32_bf16 v[240:243], a[124:127], v[80:83], v[240:243]
ds_read_b64_tr_b16 a[142:143], v11 offset:33280
buffer_load_dwordx4 v[80:83], v2, s[36:39], s97 offen offset:1024 sc1
v_mfma_f32_16x16x32_bf16 v[184:187], a[112:115], v[84:87], v[184:187]
v_mfma_f32_16x16x32_bf16 v[204:207], a[116:119], v[84:87], v[204:207]
v_mfma_f32_16x16x32_bf16 v[224:227], a[120:123], v[84:87], v[224:227]
v_mfma_f32_16x16x32_bf16 v[244:247], a[124:127], v[84:87], v[244:247]
v_lshlrev_b32 v136, 4, v12
buffer_load_dwordx4 v[84:87], v2, s[36:39], s97 offen offset:2048 sc1
v_mfma_f32_16x16x32_bf16 v[188:191], a[112:115], v[88:91], v[188:191]
v_mfma_f32_16x16x32_bf16 v[208:211], a[116:119], v[88:91], v[208:211]
v_mfma_f32_16x16x32_bf16 v[228:231], a[120:123], v[88:91], v[228:231]
v_mfma_f32_16x16x32_bf16 v[248:251], a[124:127], v[88:91], v[248:251]
v_and_b32 v12, 15, v1
buffer_load_dwordx4 v[88:91], v2, s[36:39], s97 offen offset:3072 sc1
v_mfma_f32_16x16x32_bf16 v[192:195], a[112:115], v[92:95], v[192:195]
v_mfma_f32_16x16x32_bf16 v[212:215], a[116:119], v[92:95], v[212:215]
v_mfma_f32_16x16x32_bf16 v[232:235], a[120:123], v[92:95], v[232:235]
v_mfma_f32_16x16x32_bf16 v[252:255], a[124:127], v[92:95], v[252:255]
v_lshl_add_u32 v134, v12, 4, v134
buffer_load_dwordx4 v[92:95], v3, s[36:39], s97 offen sc1
s_add_u32 s97, s97, 5120
s_cmp_eq_u32 s97, s51
s_cselect_b32 s97, s50, s97
s_waitcnt vmcnt(23)
s_waitcnt lgkmcnt(0)
v_mfma_f32_16x16x32_bf16 v[176:179], a[128:131], v[16:19], v[176:179]
ds_read_b64_tr_b16 a[144:145], v8 offset:0
v_mfma_f32_16x16x32_bf16 v[196:199], a[132:135], v[16:19], v[196:199]
ds_read_b64_tr_b16 a[146:147], v8 offset:512
v_mfma_f32_16x16x32_bf16 v[216:219], a[136:139], v[16:19], v[216:219]
ds_read_b64_tr_b16 a[148:149], v9 offset:0
v_mfma_f32_16x16x32_bf16 v[236:239], a[140:143], v[16:19], v[236:239]
ds_read_b64_tr_b16 a[150:151], v9 offset:512
buffer_load_dwordx4 v[16:19], v2, s[36:39], s97 offen offset:0 sc1
v_mfma_f32_16x16x32_bf16 v[180:183], a[128:131], v[20:23], v[180:183]
ds_read_b64_tr_b16 a[152:153], v10 offset:0
v_mfma_f32_16x16x32_bf16 v[200:203], a[132:135], v[20:23], v[200:203]
ds_read_b64_tr_b16 a[154:155], v10 offset:512
v_mfma_f32_16x16x32_bf16 v[220:223], a[136:139], v[20:23], v[220:223]
ds_read_b64_tr_b16 a[156:157], v11 offset:0
v_mfma_f32_16x16x32_bf16 v[240:243], a[140:143], v[20:23], v[240:243]
ds_read_b64_tr_b16 a[158:159], v11 offset:512
buffer_load_dwordx4 v[20:23], v2, s[36:39], s97 offen offset:1024 sc1
v_mfma_f32_16x16x32_bf16 v[184:187], a[128:131], v[24:27], v[184:187]
v_mfma_f32_16x16x32_bf16 v[204:207], a[132:135], v[24:27], v[204:207]
v_mfma_f32_16x16x32_bf16 v[224:227], a[136:139], v[24:27], v[224:227]
v_mfma_f32_16x16x32_bf16 v[244:247], a[140:143], v[24:27], v[244:247]
v_add_u32 v133, v133, v134
buffer_load_dwordx4 v[24:27], v2, s[36:39], s97 offen offset:2048 sc1
v_mfma_f32_16x16x32_bf16 v[188:191], a[128:131], v[28:31], v[188:191]
v_mfma_f32_16x16x32_bf16 v[208:211], a[132:135], v[28:31], v[208:211]
v_mfma_f32_16x16x32_bf16 v[228:231], a[136:139], v[28:31], v[228:231]
v_mfma_f32_16x16x32_bf16 v[248:251], a[140:143], v[28:31], v[248:251]
v_mul_u32_u24 v12, 1280, v12
buffer_load_dwordx4 v[28:31], v2, s[36:39], s97 offen offset:3072 sc1
v_mfma_f32_16x16x32_bf16 v[192:195], a[128:131], v[32:35], v[192:195]
v_mfma_f32_16x16x32_bf16 v[212:215], a[132:135], v[32:35], v[212:215]
v_mfma_f32_16x16x32_bf16 v[232:235], a[136:139], v[32:35], v[232:235]
v_mfma_f32_16x16x32_bf16 v[252:255], a[140:143], v[32:35], v[252:255]
v_add_u32 v136, v136, v12
buffer_load_dwordx4 v[32:35], v3, s[36:39], s97 offen sc1
s_add_u32 s97, s97, 5120
s_cmp_eq_u32 s97, s51
s_cselect_b32 s97, s50, s97
s_waitcnt vmcnt(19)
s_waitcnt lgkmcnt(0)
v_mfma_f32_16x16x32_bf16 v[176:179], a[144:147], v[36:39], v[176:179]
ds_read_b64_tr_b16 a[160:161], v8 offset:4096
v_mfma_f32_16x16x32_bf16 v[196:199], a[148:151], v[36:39], v[196:199]
ds_read_b64_tr_b16 a[162:163], v8 offset:4608
v_mfma_f32_16x16x32_bf16 v[216:219], a[152:155], v[36:39], v[216:219]
ds_read_b64_tr_b16 a[164:165], v9 offset:4096
v_mfma_f32_16x16x32_bf16 v[236:239], a[156:159], v[36:39], v[236:239]
ds_read_b64_tr_b16 a[166:167], v9 offset:4608
buffer_load_dwordx4 v[36:39], v2, s[36:39], s97 offen offset:0 sc1
v_mfma_f32_16x16x32_bf16 v[180:183], a[144:147], v[40:43], v[180:183]
ds_read_b64_tr_b16 a[168:169], v10 offset:4096
v_mfma_f32_16x16x32_bf16 v[200:203], a[148:151], v[40:43], v[200:203]
ds_read_b64_tr_b16 a[170:171], v10 offset:4608
v_mfma_f32_16x16x32_bf16 v[220:223], a[152:155], v[40:43], v[220:223]
ds_read_b64_tr_b16 a[172:173], v11 offset:4096
v_mfma_f32_16x16x32_bf16 v[240:243], a[156:159], v[40:43], v[240:243]
ds_read_b64_tr_b16 a[174:175], v11 offset:4608
buffer_load_dwordx4 v[40:43], v2, s[36:39], s97 offen offset:1024 sc1
v_mfma_f32_16x16x32_bf16 v[184:187], a[144:147], v[44:47], v[184:187]
v_mfma_f32_16x16x32_bf16 v[204:207], a[148:151], v[44:47], v[204:207]
v_mfma_f32_16x16x32_bf16 v[224:227], a[152:155], v[44:47], v[224:227]
v_mfma_f32_16x16x32_bf16 v[244:247], a[156:159], v[44:47], v[244:247]
v_add_u32 v135, v135, v136
buffer_load_dwordx4 v[44:47], v2, s[36:39], s97 offen offset:2048 sc1
v_mfma_f32_16x16x32_bf16 v[188:191], a[144:147], v[48:51], v[188:191]
v_mfma_f32_16x16x32_bf16 v[208:211], a[148:151], v[48:51], v[208:211]
v_mfma_f32_16x16x32_bf16 v[228:231], a[152:155], v[48:51], v[228:231]
v_mfma_f32_16x16x32_bf16 v[248:251], a[156:159], v[48:51], v[248:251]
s_mul_i32 s42, s94, 54
buffer_load_dwordx4 v[48:51], v2, s[36:39], s97 offen offset:3072 sc1
v_mfma_f32_16x16x32_bf16 v[192:195], a[144:147], v[52:55], v[192:195]
v_mfma_f32_16x16x32_bf16 v[212:215], a[148:151], v[52:55], v[212:215]
v_mfma_f32_16x16x32_bf16 v[232:235], a[152:155], v[52:55], v[232:235]
v_mfma_f32_16x16x32_bf16 v[252:255], a[156:159], v[52:55], v[252:255]
s_lshl_b32 s43, s5, 1
buffer_load_dwordx4 v[52:55], v3, s[36:39], s97 offen sc1
s_add_u32 s97, s97, 5120
s_cmp_eq_u32 s97, s51
s_cselect_b32 s97, s50, s97
s_waitcnt vmcnt(15)
s_waitcnt lgkmcnt(0)
v_mfma_f32_16x16x32_bf16 v[176:179], a[160:163], v[56:59], v[176:179]
ds_read_b64_tr_b16 a[176:177], v8 offset:8192
v_mfma_f32_16x16x32_bf16 v[196:199], a[164:167], v[56:59], v[196:199]
ds_read_b64_tr_b16 a[178:179], v8 offset:8704
v_mfma_f32_16x16x32_bf16 v[216:219], a[168:171], v[56:59], v[216:219]
ds_read_b64_tr_b16 a[180:181], v9 offset:8192
v_mfma_f32_16x16x32_bf16 v[236:239], a[172:175], v[56:59], v[236:239]
ds_read_b64_tr_b16 a[182:183], v9 offset:8704
buffer_load_dwordx4 v[56:59], v2, s[36:39], s97 offen offset:0 sc1
v_mfma_f32_16x16x32_bf16 v[180:183], a[160:163], v[60:63], v[180:183]
ds_read_b64_tr_b16 a[184:185], v10 offset:8192
v_mfma_f32_16x16x32_bf16 v[200:203], a[164:167], v[60:63], v[200:203]
ds_read_b64_tr_b16 a[186:187], v10 offset:8704
v_mfma_f32_16x16x32_bf16 v[220:223], a[168:171], v[60:63], v[220:223]
ds_read_b64_tr_b16 a[188:189], v11 offset:8192
v_mfma_f32_16x16x32_bf16 v[240:243], a[172:175], v[60:63], v[240:243]
ds_read_b64_tr_b16 a[190:191], v11 offset:8704
buffer_load_dwordx4 v[60:63], v2, s[36:39], s97 offen offset:1024 sc1
v_mfma_f32_16x16x32_bf16 v[184:187], a[160:163], v[64:67], v[184:187]
v_mfma_f32_16x16x32_bf16 v[204:207], a[164:167], v[64:67], v[204:207]
v_mfma_f32_16x16x32_bf16 v[224:227], a[168:171], v[64:67], v[224:227]
v_mfma_f32_16x16x32_bf16 v[244:247], a[172:175], v[64:67], v[244:247]
s_add_u32 s42, s42, s43
buffer_load_dwordx4 v[64:67], v2, s[36:39], s97 offen offset:2048 sc1
v_mfma_f32_16x16x32_bf16 v[188:191], a[160:163], v[68:71], v[188:191]
v_mfma_f32_16x16x32_bf16 v[208:211], a[164:167], v[68:71], v[208:211]
v_mfma_f32_16x16x32_bf16 v[228:231], a[168:171], v[68:71], v[228:231]
v_mfma_f32_16x16x32_bf16 v[248:251], a[172:175], v[68:71], v[248:251]
s_lshr_b32 s43, s3, 1
buffer_load_dwordx4 v[68:71], v2, s[36:39], s97 offen offset:3072 sc1
v_mfma_f32_16x16x32_bf16 v[192:195], a[160:163], v[72:75], v[192:195]
v_mfma_f32_16x16x32_bf16 v[212:215], a[164:167], v[72:75], v[212:215]
v_mfma_f32_16x16x32_bf16 v[232:235], a[168:171], v[72:75], v[232:235]
v_mfma_f32_16x16x32_bf16 v[252:255], a[172:175], v[72:75], v[252:255]
s_add_u32 s42, s42, s43
buffer_load_dwordx4 v[72:75], v3, s[36:39], s97 offen sc1
s_add_u32 s97, s97, 5120
s_cmp_eq_u32 s97, s51
s_cselect_b32 s97, s50, s97
s_waitcnt vmcnt(15)
s_waitcnt lgkmcnt(0)
v_mfma_f32_16x16x32_bf16 v[176:179], a[176:179], v[76:79], v[176:179]
ds_read_b64_tr_b16 a[192:193], v8 offset:12288
v_mfma_f32_16x16x32_bf16 v[196:199], a[180:183], v[76:79], v[196:199]
ds_read_b64_tr_b16 a[194:195], v8 offset:12800
v_mfma_f32_16x16x32_bf16 v[216:219], a[184:187], v[76:79], v[216:219]
ds_read_b64_tr_b16 a[196:197], v9 offset:12288
v_mfma_f32_16x16x32_bf16 v[236:239], a[188:191], v[76:79], v[236:239]
ds_read_b64_tr_b16 a[198:199], v9 offset:12800
buffer_load_dwordx4 v[76:79], v2, s[36:39], s97 offen offset:0 sc1
v_mfma_f32_16x16x32_bf16 v[180:183], a[176:179], v[80:83], v[180:183]
ds_read_b64_tr_b16 a[200:201], v10 offset:12288
v_mfma_f32_16x16x32_bf16 v[200:203], a[180:183], v[80:83], v[200:203]
ds_read_b64_tr_b16 a[202:203], v10 offset:12800
v_mfma_f32_16x16x32_bf16 v[220:223], a[184:187], v[80:83], v[220:223]
ds_read_b64_tr_b16 a[204:205], v11 offset:12288
v_mfma_f32_16x16x32_bf16 v[240:243], a[188:191], v[80:83], v[240:243]
ds_read_b64_tr_b16 a[206:207], v11 offset:12800
buffer_load_dwordx4 v[80:83], v2, s[36:39], s97 offen offset:1024 sc1
v_mfma_f32_16x16x32_bf16 v[184:187], a[176:179], v[84:87], v[184:187]
v_mfma_f32_16x16x32_bf16 v[204:207], a[180:183], v[84:87], v[204:207]
v_mfma_f32_16x16x32_bf16 v[224:227], a[184:187], v[84:87], v[224:227]
v_mfma_f32_16x16x32_bf16 v[244:247], a[188:191], v[84:87], v[244:247]
s_mul_i32 s42, s42, 5120
buffer_load_dwordx4 v[84:87], v2, s[36:39], s97 offen offset:2048 sc1
v_mfma_f32_16x16x32_bf16 v[188:191], a[176:179], v[88:91], v[188:191]
v_mfma_f32_16x16x32_bf16 v[208:211], a[180:183], v[88:91], v[208:211]
v_mfma_f32_16x16x32_bf16 v[228:231], a[184:187], v[88:91], v[228:231]
v_mfma_f32_16x16x32_bf16 v[248:251], a[188:191], v[88:91], v[248:251]
s_and_b32 s43, s3, 1
buffer_load_dwordx4 v[88:91], v2, s[36:39], s97 offen offset:3072 sc1
v_mfma_f32_16x16x32_bf16 v[192:195], a[176:179], v[92:95], v[192:195]
v_mfma_f32_16x16x32_bf16 v[212:215], a[180:183], v[92:95], v[212:215]
v_mfma_f32_16x16x32_bf16 v[232:235], a[184:187], v[92:95], v[232:235]
v_mfma_f32_16x16x32_bf16 v[252:255], a[188:191], v[92:95], v[252:255]
s_lshl_b32 s43, s43, 9
buffer_load_dwordx4 v[92:95], v3, s[36:39], s97 offen sc1
s_add_u32 s97, s97, 5120
s_cmp_eq_u32 s97, s51
s_cselect_b32 s97, s50, s97
s_add_u32 s42, s42, s43
s_add_u32 s54, s42, 2621440
s_lshl_b32 s42, s6, 2
s_add_u32 s42, s42, s3
s_mul_i32 s42, s42, 20480
s_mul_i32 s43, s4, 160
s_add_u32 s55, s42, s43
v_mov_b32 v144, 0xc0135761
v_mov_b32 v145, 0xc0135761
v_mov_b32 v146, 0xbdd2d3e8
v_mov_b32 v147, 0xbdd2d3e8
v_mov_b32 v148, 1.0
v_mov_b32 v149, 1.0
v_lshrrev_b32 v12, 3, v1
v_and_b32 v13, 2, v12
v_mul_u32_u24 v12, 4096, v12
v_and_b32 v130, 7, v1
v_xor_b32 v13, v13, v130
v_lshl_add_u32 v128, v13, 4, v12
v_xor_b32 v13, 4, v13
v_lshl_add_u32 v129, v13, 4, v12
v_add_u32 v129, 32768, v129
v_add_u32 v130, 65536, v128
v_add_u32 v131, 65536, v129
s_mov_b32 s52, 0
s_mul_i32 s42, s3, 14
s_cmp_eq_u32 s3, 3
s_cselect_b32 s45, 1, 0
s_sub_u32 s42, s42, s45
s_mul_i32 s95, s42, 131072
s_lshl_b32 s42, s6, 7
s_add_u32 s95, s95, s42
s_add_u32 s53, s95, 1703936
s_mul_i32 s99, s52, 131072
s_add_u32 s99, s99, s95
s_lshl_b32 s42, s6, 7
s_lshl_b32 s43, s3, 5
s_add_u32 s42, s42, s43
v_and_b32 v12, 15, v1
v_lshlrev_b32 v12, 1, v12
buffer_load_ushort v132, v12, s[24:27], s42 offen
s_waitcnt vmcnt(16)
s_waitcnt lgkmcnt(0)
v_mfma_f32_16x16x32_bf16 v[176:179], a[192:195], v[16:19], v[176:179]
ds_read_b64_tr_b16 a[208:209], v8 offset:16384
v_mfma_f32_16x16x32_bf16 v[196:199], a[196:199], v[16:19], v[196:199]
ds_read_b64_tr_b16 a[210:211], v8 offset:16896
v_mfma_f32_16x16x32_bf16 v[216:219], a[200:203], v[16:19], v[216:219]
ds_read_b64_tr_b16 a[212:213], v9 offset:16384
v_mfma_f32_16x16x32_bf16 v[236:239], a[204:207], v[16:19], v[236:239]
ds_read_b64_tr_b16 a[214:215], v9 offset:16896
s_add_u32 m0, s46, 0
s_nop 0
buffer_load_dwordx4 v128, s[16:19], s99 offen lds
s_add_u32 m0, s46, 1024
v_mfma_f32_16x16x32_bf16 v[180:183], a[192:195], v[20:23], v[180:183]
ds_read_b64_tr_b16 a[216:217], v10 offset:16384
v_mfma_f32_16x16x32_bf16 v[200:203], a[196:199], v[20:23], v[200:203]
ds_read_b64_tr_b16 a[218:219], v10 offset:16896
v_mfma_f32_16x16x32_bf16 v[220:223], a[200:203], v[20:23], v[220:223]
ds_read_b64_tr_b16 a[220:221], v11 offset:16384
v_mfma_f32_16x16x32_bf16 v[240:243], a[204:207], v[20:23], v[240:243]
ds_read_b64_tr_b16 a[222:223], v11 offset:16896
buffer_load_dwordx4 v129, s[16:19], s99 offen lds
s_add_u32 m0, s46, 2048
v_mfma_f32_16x16x32_bf16 v[184:187], a[192:195], v[24:27], v[184:187]
v_mfma_f32_16x16x32_bf16 v[204:207], a[196:199], v[24:27], v[204:207]
v_mfma_f32_16x16x32_bf16 v[224:227], a[200:203], v[24:27], v[224:227]
v_mfma_f32_16x16x32_bf16 v[244:247], a[204:207], v[24:27], v[244:247]
buffer_load_dwordx4 v130, s[16:19], s99 offen lds
s_add_u32 m0, s46, 3072
v_mfma_f32_16x16x32_bf16 v[188:191], a[192:195], v[28:31], v[188:191]
v_mfma_f32_16x16x32_bf16 v[208:211], a[196:199], v[28:31], v[208:211]
v_mfma_f32_16x16x32_bf16 v[228:231], a[200:203], v[28:31], v[228:231]
v_mfma_f32_16x16x32_bf16 v[248:251], a[204:207], v[28:31], v[248:251]
buffer_load_dwordx4 v131, s[16:19], s99 offen lds
s_add_u32 m0, s46, 4096
s_add_u32 s99, s99, 131072
s_cmp_eq_u32 s99, s53
s_cselect_b32 s99, s95, s99
v_mfma_f32_16x16x32_bf16 v[192:195], a[192:195], v[32:35], v[192:195]
v_mfma_f32_16x16x32_bf16 v[212:215], a[196:199], v[32:35], v[212:215]
v_mfma_f32_16x16x32_bf16 v[232:235], a[200:203], v[32:35], v[232:235]
v_mfma_f32_16x16x32_bf16 v[252:255], a[204:207], v[32:35], v[252:255]
buffer_load_dwordx4 v128, s[16:19], s99 offen lds
s_add_u32 m0, s46, 5120
s_waitcnt vmcnt(16)
s_waitcnt lgkmcnt(0)
v_mfma_f32_16x16x32_bf16 v[176:179], a[208:211], v[36:39], v[176:179]
ds_read_b64_tr_b16 a[224:225], v8 offset:20480
v_mfma_f32_16x16x32_bf16 v[196:199], a[212:215], v[36:39], v[196:199]
ds_read_b64_tr_b16 a[226:227], v8 offset:20992
v_mfma_f32_16x16x32_bf16 v[216:219], a[216:219], v[36:39], v[216:219]
ds_read_b64_tr_b16 a[228:229], v9 offset:20480
v_mfma_f32_16x16x32_bf16 v[236:239], a[220:223], v[36:39], v[236:239]
ds_read_b64_tr_b16 a[230:231], v9 offset:20992
buffer_load_dwordx4 v129, s[16:19], s99 offen lds
s_add_u32 m0, s46, 6144
v_mfma_f32_16x16x32_bf16 v[180:183], a[208:211], v[40:43], v[180:183]
ds_read_b64_tr_b16 a[232:233], v10 offset:20480
v_mfma_f32_16x16x32_bf16 v[200:203], a[212:215], v[40:43], v[200:203]
ds_read_b64_tr_b16 a[234:235], v10 offset:20992
v_mfma_f32_16x16x32_bf16 v[220:223], a[216:219], v[40:43], v[220:223]
ds_read_b64_tr_b16 a[236:237], v11 offset:20480
v_mfma_f32_16x16x32_bf16 v[240:243], a[220:223], v[40:43], v[240:243]
ds_read_b64_tr_b16 a[238:239], v11 offset:20992
buffer_load_dwordx4 v130, s[16:19], s99 offen lds
s_add_u32 m0, s46, 7168
v_mfma_f32_16x16x32_bf16 v[184:187], a[208:211], v[44:47], v[184:187]
v_mfma_f32_16x16x32_bf16 v[204:207], a[212:215], v[44:47], v[204:207]
v_mfma_f32_16x16x32_bf16 v[224:227], a[216:219], v[44:47], v[224:227]
v_mfma_f32_16x16x32_bf16 v[244:247], a[220:223], v[44:47], v[244:247]
buffer_load_dwordx4 v131, s[16:19], s99 offen lds
s_add_u32 m0, s46, 8192
s_add_u32 s99, s99, 131072
s_cmp_eq_u32 s99, s53
s_cselect_b32 s99, s95, s99
v_mfma_f32_16x16x32_bf16 v[188:191], a[208:211], v[48:51], v[188:191]
v_mfma_f32_16x16x32_bf16 v[208:211], a[212:215], v[48:51], v[208:211]
v_mfma_f32_16x16x32_bf16 v[228:231], a[216:219], v[48:51], v[228:231]
v_mfma_f32_16x16x32_bf16 v[248:251], a[220:223], v[48:51], v[248:251]
buffer_load_dwordx4 v128, s[16:19], s99 offen lds
s_add_u32 m0, s46, 9216
v_mfma_f32_16x16x32_bf16 v[192:195], a[208:211], v[52:55], v[192:195]
v_mfma_f32_16x16x32_bf16 v[212:215], a[212:215], v[52:55], v[212:215]
v_mfma_f32_16x16x32_bf16 v[232:235], a[216:219], v[52:55], v[232:235]
v_mfma_f32_16x16x32_bf16 v[252:255], a[220:223], v[52:55], v[252:255]
buffer_load_dwordx4 v129, s[16:19], s99 offen lds
s_add_u32 m0, s46, 10240
ds_read_b64_tr_b16 a[240:241], v8 offset:24576
ds_read_b64_tr_b16 a[242:243], v8 offset:25088
ds_read_b64_tr_b16 a[244:245], v9 offset:24576
ds_read_b64_tr_b16 a[246:247], v9 offset:25088
ds_read_b64_tr_b16 a[248:249], v10 offset:24576
ds_read_b64_tr_b16 a[250:251], v10 offset:25088
ds_read_b64_tr_b16 a[252:253], v11 offset:24576
ds_read_b64_tr_b16 a[254:255], v11 offset:25088
s_waitcnt vmcnt(11)
s_waitcnt lgkmcnt(0)
s_barrier
v_mfma_f32_16x16x32_bf16 v[196:199], a[228:231], v[56:59], v[196:199]
v_mfma_f32_16x16x32_bf16 v[200:203], a[228:231], v[60:63], v[200:203]
v_mfma_f32_16x16x32_bf16 v[204:207], a[228:231], v[64:67], v[204:207]
v_mfma_f32_16x16x32_bf16 v[208:211], a[228:231], v[68:71], v[208:211]
buffer_load_dwordx4 v130, s[16:19], s99 offen lds
s_add_u32 m0, s46, 11264
v_mfma_f32_16x16x32_bf16 v[212:215], a[228:231], v[72:75], v[212:215]
v_mfma_f32_16x16x32_bf16 v[196:199], a[244:247], v[76:79], v[196:199]
v_mfma_f32_16x16x32_bf16 v[200:203], a[244:247], v[80:83], v[200:203]
v_mfma_f32_16x16x32_bf16 v[204:207], a[244:247], v[84:87], v[204:207]
buffer_load_dwordx4 v131, s[16:19], s99 offen lds
s_add_u32 m0, s46, 12288
s_add_u32 s99, s99, 131072
s_cmp_eq_u32 s99, s53
s_cselect_b32 s99, s95, s99
v_mfma_f32_16x16x32_bf16 v[208:211], a[244:247], v[88:91], v[208:211]
v_mfma_f32_16x16x32_bf16 v[212:215], a[244:247], v[92:95], v[212:215]
v_mfma_f32_16x16x32_bf16 v[216:219], a[232:235], v[56:59], v[216:219]
v_mfma_f32_16x16x32_bf16 v[220:223], a[232:235], v[60:63], v[220:223]
buffer_load_dwordx4 v128, s[16:19], s99 offen lds
s_add_u32 m0, s46, 13312
v_mfma_f32_16x16x32_bf16 v[224:227], a[232:235], v[64:67], v[224:227]
v_mfma_f32_16x16x32_bf16 v[228:231], a[232:235], v[68:71], v[228:231]
ds_write_b128 v137, v[196:199] offset:0
v_mfma_f32_16x16x32_bf16 v[232:235], a[232:235], v[72:75], v[232:235]
ds_write_b128 v137, v[200:203] offset:1024
v_mfma_f32_16x16x32_bf16 v[216:219], a[248:251], v[76:79], v[216:219]
ds_write_b128 v137, v[204:207] offset:2048
buffer_load_dwordx4 v129, s[16:19], s99 offen lds
s_add_u32 m0, s46, 14336
v_mfma_f32_16x16x32_bf16 v[220:223], a[248:251], v[80:83], v[220:223]
ds_write_b128 v137, v[208:211] offset:3072
v_mfma_f32_16x16x32_bf16 v[224:227], a[248:251], v[84:87], v[224:227]
ds_write_b128 v137, v[212:215] offset:4096
v_mfma_f32_16x16x32_bf16 v[228:231], a[248:251], v[88:91], v[228:231]
v_mfma_f32_16x16x32_bf16 v[232:235], a[248:251], v[92:95], v[232:235]
buffer_load_dwordx4 v130, s[16:19], s99 offen lds
s_add_u32 m0, s46, 15360
v_mfma_f32_16x16x32_bf16 v[236:239], a[236:239], v[56:59], v[236:239]
v_mfma_f32_16x16x32_bf16 v[240:243], a[236:239], v[60:63], v[240:243]
v_mfma_f32_16x16x32_bf16 v[244:247], a[236:239], v[64:67], v[244:247]
v_mfma_f32_16x16x32_bf16 v[248:251], a[236:239], v[68:71], v[248:251]
ds_write_b128 v138, v[216:219] offset:5120
buffer_load_dwordx4 v131, s[16:19], s99 offen lds
s_add_u32 m0, s46, 16384
s_add_u32 s99, s99, 131072
s_cmp_eq_u32 s99, s53
s_cselect_b32 s99, s95, s99
v_mfma_f32_16x16x32_bf16 v[252:255], a[236:239], v[72:75], v[252:255]
ds_write_b128 v138, v[220:223] offset:6144
v_mfma_f32_16x16x32_bf16 v[236:239], a[252:255], v[76:79], v[236:239]
ds_write_b128 v138, v[224:227] offset:7168
v_mfma_f32_16x16x32_bf16 v[240:243], a[252:255], v[80:83], v[240:243]
ds_write_b128 v138, v[228:231] offset:8192
v_mfma_f32_16x16x32_bf16 v[244:247], a[252:255], v[84:87], v[244:247]
ds_write_b128 v138, v[232:235] offset:9216
buffer_load_dwordx4 v128, s[16:19], s99 offen lds
s_add_u32 m0, s46, 17408
v_mfma_f32_16x16x32_bf16 v[248:251], a[252:255], v[88:91], v[248:251]
v_mfma_f32_16x16x32_bf16 v[252:255], a[252:255], v[92:95], v[252:255]
v_mfma_f32_16x16x32_bf16 v[176:179], a[224:227], v[56:59], v[176:179]
v_mfma_f32_16x16x32_bf16 v[180:183], a[224:227], v[60:63], v[180:183]
buffer_load_dwordx4 v129, s[16:19], s99 offen lds
s_add_u32 m0, s46, 18432
v_mfma_f32_16x16x32_bf16 v[184:187], a[224:227], v[64:67], v[184:187]
v_mfma_f32_16x16x32_bf16 v[188:191], a[224:227], v[68:71], v[188:191]
ds_write_b128 v139, v[236:239] offset:10240
v_mfma_f32_16x16x32_bf16 v[192:195], a[224:227], v[72:75], v[192:195]
ds_write_b128 v139, v[240:243] offset:11264
v_mfma_f32_16x16x32_bf16 v[176:179], a[240:243], v[76:79], v[176:179]
ds_write_b128 v140, v[244:247] offset:0
buffer_load_dwordx4 v130, s[16:19], s99 offen lds
s_add_u32 m0, s46, 19456
v_mfma_f32_16x16x32_bf16 v[180:183], a[240:243], v[80:83], v[180:183]
ds_write_b128 v140, v[248:251] offset:1024
v_mfma_f32_16x16x32_bf16 v[184:187], a[240:243], v[84:87], v[184:187]
ds_write_b128 v140, v[252:255] offset:2048
v_mfma_f32_16x16x32_bf16 v[188:191], a[240:243], v[88:91], v[188:191]
v_mfma_f32_16x16x32_bf16 v[192:195], a[240:243], v[92:95], v[192:195]
buffer_load_dwordx4 v131, s[16:19], s99 offen lds
s_add_u32 m0, s46, 20480
s_add_u32 s99, s99, 131072
s_cmp_eq_u32 s99, s53
s_cselect_b32 s99, s95, s99
buffer_load_dwordx4 v128, s[16:19], s99 offen lds
s_add_u32 m0, s46, 21504
s_nop 0
buffer_load_dwordx4 v129, s[16:19], s99 offen lds
s_add_u32 m0, s46, 22528
s_nop 0
buffer_load_dwordx4 v130, s[16:19], s99 offen lds
s_add_u32 m0, s46, 23552
s_nop 0
buffer_load_dwordx4 v131, s[16:19], s99 offen lds
s_add_u32 m0, s46, 0
s_add_u32 s99, s99, 131072
s_cmp_eq_u32 s99, s53
s_cselect_b32 s99, s95, s99
s_waitcnt vmcnt(20)
ds_read_b64_tr_b16 a[0:1], v8 offset:0
ds_read_b64_tr_b16 a[2:3], v8 offset:512
ds_read_b64_tr_b16 a[4:5], v9 offset:0
ds_read_b64_tr_b16 a[6:7], v9 offset:512
ds_read_b64_tr_b16 a[8:9], v10 offset:0
ds_read_b64_tr_b16 a[10:11], v10 offset:512
ds_read_b64_tr_b16 a[12:13], v11 offset:0
ds_read_b64_tr_b16 a[14:15], v11 offset:512
s_waitcnt vmcnt(16)
ds_read_b64_tr_b16 a[16:17], v8 offset:4096
ds_read_b64_tr_b16 a[18:19], v8 offset:4608
ds_read_b64_tr_b16 a[20:21], v9 offset:4096
ds_read_b64_tr_b16 a[22:23], v9 offset:4608
ds_read_b64_tr_b16 a[24:25], v10 offset:4096
ds_read_b64_tr_b16 a[26:27], v10 offset:4608
ds_read_b64_tr_b16 a[28:29], v11 offset:4096
ds_read_b64_tr_b16 a[30:31], v11 offset:4608
s_waitcnt vmcnt(12)
ds_read_b64_tr_b16 a[32:33], v8 offset:8192
ds_read_b64_tr_b16 a[34:35], v8 offset:8704
ds_read_b64_tr_b16 a[36:37], v9 offset:8192
ds_read_b64_tr_b16 a[38:39], v9 offset:8704
ds_read_b64_tr_b16 a[40:41], v10 offset:8192
ds_read_b64_tr_b16 a[42:43], v10 offset:8704
ds_read_b64_tr_b16 a[44:45], v11 offset:8192
ds_read_b64_tr_b16 a[46:47], v11 offset:8704
s_waitcnt lgkmcnt(0)
s_barrier
ds_read_b128 v[16:19], v141 offset:0
ds_read_b128 v[36:39], v141 offset:5120
ds_read_b128 v[56:59], v141 offset:10240
buffer_load_dwordx4 v128, s[16:19], s99 offen lds
s_add_u32 m0, s46, 1024
ds_read_b128 v[20:23], v141 offset:1024
ds_read_b128 v[40:43], v141 offset:6144
ds_read_b128 v[60:63], v141 offset:11264
buffer_load_dwordx4 v129, s[16:19], s99 offen lds
s_add_u32 m0, s46, 2048
s_nop 0
buffer_load_dwordx4 v130, s[16:19], s99 offen lds
s_add_u32 m0, s46, 3072
ds_read_b128 v[24:27], v141 offset:2048
ds_read_b128 v[44:47], v141 offset:7168
ds_read_b128 v[64:67], v142 offset:0
buffer_load_dwordx4 v131, s[16:19], s99 offen lds
s_add_u32 m0, s46, 4096
s_add_u32 s99, s99, 131072
s_cmp_eq_u32 s99, s53
s_cselect_b32 s99, s95, s99
ds_read_b128 v[28:31], v141 offset:3072
ds_read_b128 v[48:51], v141 offset:8192
ds_read_b128 v[68:71], v142 offset:1024
buffer_load_dwordx4 v128, s[16:19], s99 offen lds
s_add_u32 m0, s46, 5120
s_nop 0
buffer_load_dwordx4 v129, s[16:19], s99 offen lds
s_add_u32 m0, s46, 6144
ds_read_b128 v[32:35], v141 offset:4096
ds_read_b128 v[52:55], v141 offset:9216
ds_read_b128 v[72:75], v142 offset:2048
buffer_load_dwordx4 v130, s[16:19], s99 offen lds
s_add_u32 m0, s46, 7168
s_waitcnt lgkmcnt(12)
v_pk_add_f32 v[176:177], v[176:177], v[16:17]
v_pk_add_f32 v[178:179], v[178:179], v[18:19]
buffer_load_dwordx4 v131, s[16:19], s99 offen lds
s_add_u32 m0, s46, 8192
s_add_u32 s99, s99, 131072
s_cmp_eq_u32 s99, s53
s_cselect_b32 s99, s95, s99
v_pk_add_f32 v[176:177], v[176:177], v[36:37]
v_pk_add_f32 v[178:179], v[178:179], v[38:39]
v_pk_add_f32 v[176:177], v[176:177], v[56:57]
v_pk_add_f32 v[178:179], v[178:179], v[58:59]
buffer_load_dwordx4 v128, s[16:19], s99 offen lds
s_add_u32 m0, s46, 9216
v_pk_mul_f32 v[100:101], v[176:177], v[176:177]
v_pk_mul_f32 v[102:103], v[178:179], v[178:179]
v_pk_fma_f32 v[100:101], v[100:101], v[146:147], v[144:145]
v_pk_fma_f32 v[102:103], v[102:103], v[146:147], v[144:145]
buffer_load_dwordx4 v129, s[16:19], s99 offen lds
s_add_u32 m0, s46, 10240
v_pk_mul_f32 v[100:101], v[100:101], v[176:177]
v_pk_mul_f32 v[102:103], v[102:103], v[178:179]
v_exp_f32 v100, v100
v_exp_f32 v101, v101
v_exp_f32 v102, v102
v_exp_f32 v103, v103
buffer_load_dwordx4 v130, s[16:19], s99 offen lds
s_add_u32 m0, s46, 11264
s_nop 0
buffer_load_dwordx4 v131, s[16:19], s99 offen lds
s_add_u32 m0, s46, 12288
s_add_u32 s99, s99, 131072
s_cmp_eq_u32 s99, s53
s_cselect_b32 s99, s95, s99
v_pk_add_f32 v[100:101], v[100:101], v[148:149]
v_pk_add_f32 v[102:103], v[102:103], v[148:149]
v_rcp_f32 v100, v100
v_rcp_f32 v101, v101
v_rcp_f32 v102, v102
v_rcp_f32 v103, v103
s_nop 0
v_pk_mul_f32 v[176:177], v[176:177], v[100:101]
v_pk_mul_f32 v[178:179], v[178:179], v[102:103]
v_cvt_pk_bf16_f32 v80, v176, v177
v_cvt_pk_bf16_f32 v81, v178, v179
s_waitcnt lgkmcnt(9)
v_pk_add_f32 v[180:181], v[180:181], v[20:21]
v_pk_add_f32 v[182:183], v[182:183], v[22:23]
v_pk_add_f32 v[180:181], v[180:181], v[40:41]
v_pk_add_f32 v[182:183], v[182:183], v[42:43]
v_pk_add_f32 v[180:181], v[180:181], v[60:61]
v_pk_add_f32 v[182:183], v[182:183], v[62:63]
v_pk_mul_f32 v[104:105], v[180:181], v[180:181]
v_pk_mul_f32 v[106:107], v[182:183], v[182:183]
v_pk_fma_f32 v[104:105], v[104:105], v[146:147], v[144:145]
v_pk_fma_f32 v[106:107], v[106:107], v[146:147], v[144:145]
v_pk_mul_f32 v[104:105], v[104:105], v[180:181]
v_pk_mul_f32 v[106:107], v[106:107], v[182:183]
v_exp_f32 v104, v104
v_exp_f32 v105, v105
v_exp_f32 v106, v106
v_exp_f32 v107, v107
v_pk_add_f32 v[104:105], v[104:105], v[148:149]
v_pk_add_f32 v[106:107], v[106:107], v[148:149]
v_rcp_f32 v104, v104
v_rcp_f32 v105, v105
v_rcp_f32 v106, v106
v_rcp_f32 v107, v107
s_nop 0
v_pk_mul_f32 v[180:181], v[180:181], v[104:105]
v_pk_mul_f32 v[182:183], v[182:183], v[106:107]
v_cvt_pk_bf16_f32 v82, v180, v181
v_cvt_pk_bf16_f32 v83, v182, v183
s_nop 1
v_permlane16_swap_b32 v80, v82
v_permlane16_swap_b32 v81, v83
buffer_store_dwordx4 v[80:83], v133, s[36:39], s54 offen offset:0 sc1
s_waitcnt lgkmcnt(6)
v_pk_add_f32 v[184:185], v[184:185], v[24:25]
v_pk_add_f32 v[186:187], v[186:187], v[26:27]
v_pk_add_f32 v[184:185], v[184:185], v[44:45]
v_pk_add_f32 v[186:187], v[186:187], v[46:47]
v_pk_add_f32 v[184:185], v[184:185], v[64:65]
v_pk_add_f32 v[186:187], v[186:187], v[66:67]
v_pk_mul_f32 v[100:101], v[184:185], v[184:185]
v_pk_mul_f32 v[102:103], v[186:187], v[186:187]
v_pk_fma_f32 v[100:101], v[100:101], v[146:147], v[144:145]
v_pk_fma_f32 v[102:103], v[102:103], v[146:147], v[144:145]
v_pk_mul_f32 v[100:101], v[100:101], v[184:185]
v_pk_mul_f32 v[102:103], v[102:103], v[186:187]
v_exp_f32 v100, v100
v_exp_f32 v101, v101
v_exp_f32 v102, v102
v_exp_f32 v103, v103
v_pk_add_f32 v[100:101], v[100:101], v[148:149]
v_pk_add_f32 v[102:103], v[102:103], v[148:149]
v_rcp_f32 v100, v100
v_rcp_f32 v101, v101
v_rcp_f32 v102, v102
v_rcp_f32 v103, v103
s_nop 0
v_pk_mul_f32 v[184:185], v[184:185], v[100:101]
v_pk_mul_f32 v[186:187], v[186:187], v[102:103]
v_cvt_pk_bf16_f32 v84, v184, v185
v_cvt_pk_bf16_f32 v85, v186, v187
s_waitcnt lgkmcnt(3)
v_pk_add_f32 v[188:189], v[188:189], v[28:29]
v_pk_add_f32 v[190:191], v[190:191], v[30:31]
v_pk_add_f32 v[188:189], v[188:189], v[48:49]
v_pk_add_f32 v[190:191], v[190:191], v[50:51]
v_pk_add_f32 v[188:189], v[188:189], v[68:69]
v_pk_add_f32 v[190:191], v[190:191], v[70:71]
v_pk_mul_f32 v[104:105], v[188:189], v[188:189]
v_pk_mul_f32 v[106:107], v[190:191], v[190:191]
v_pk_fma_f32 v[104:105], v[104:105], v[146:147], v[144:145]
v_pk_fma_f32 v[106:107], v[106:107], v[146:147], v[144:145]
v_pk_mul_f32 v[104:105], v[104:105], v[188:189]
v_pk_mul_f32 v[106:107], v[106:107], v[190:191]
v_exp_f32 v104, v104
v_exp_f32 v105, v105
v_exp_f32 v106, v106
v_exp_f32 v107, v107
v_pk_add_f32 v[104:105], v[104:105], v[148:149]
v_pk_add_f32 v[106:107], v[106:107], v[148:149]
v_rcp_f32 v104, v104
v_rcp_f32 v105, v105
v_rcp_f32 v106, v106
v_rcp_f32 v107, v107
s_nop 0
v_pk_mul_f32 v[188:189], v[188:189], v[104:105]
v_pk_mul_f32 v[190:191], v[190:191], v[106:107]
v_cvt_pk_bf16_f32 v86, v188, v189
v_cvt_pk_bf16_f32 v87, v190, v191
s_nop 1
v_permlane16_swap_b32 v84, v86
v_permlane16_swap_b32 v85, v87
buffer_store_dwordx4 v[84:87], v133, s[36:39], s54 offen offset:2048 sc1
s_waitcnt lgkmcnt(0)
v_pk_add_f32 v[192:193], v[192:193], v[32:33]
v_pk_add_f32 v[194:195], v[194:195], v[34:35]
v_pk_add_f32 v[192:193], v[192:193], v[52:53]
v_pk_add_f32 v[194:195], v[194:195], v[54:55]
v_pk_add_f32 v[192:193], v[192:193], v[72:73]
v_pk_add_f32 v[194:195], v[194:195], v[74:75]
v_pk_mul_f32 v[100:101], v[192:193], v[192:193]
v_pk_mul_f32 v[102:103], v[194:195], v[194:195]
v_pk_fma_f32 v[100:101], v[100:101], v[146:147], v[144:145]
v_pk_fma_f32 v[102:103], v[102:103], v[146:147], v[144:145]
v_pk_mul_f32 v[100:101], v[100:101], v[192:193]
v_pk_mul_f32 v[102:103], v[102:103], v[194:195]
v_exp_f32 v100, v100
v_exp_f32 v101, v101
v_exp_f32 v102, v102
v_exp_f32 v103, v103
v_pk_add_f32 v[100:101], v[100:101], v[148:149]
v_pk_add_f32 v[102:103], v[102:103], v[148:149]
v_rcp_f32 v100, v100
v_rcp_f32 v101, v101
v_rcp_f32 v102, v102
v_rcp_f32 v103, v103
s_nop 0
v_pk_mul_f32 v[192:193], v[192:193], v[100:101]
v_pk_mul_f32 v[194:195], v[194:195], v[102:103]
v_cvt_pk_bf16_f32 v88, v192, v193
v_cvt_pk_bf16_f32 v89, v194, v195
v_mov_b32 v90, v88
v_mov_b32 v91, v89
s_add_u32 s43, s54, 4096
s_nop 0
v_permlane16_swap_b32 v88, v90
v_permlane16_swap_b32 v89, v91
buffer_store_dwordx4 v[88:91], v134, s[36:39], s43 offen sc1
s_waitcnt lgkmcnt(0)
s_mov_b32 s52, 0
s_mul_i32 s42, s3, 14
s_cmp_eq_u32 s3, 3
s_cselect_b32 s45, 1, 0
s_sub_u32 s42, s42, s45
s_mul_i32 s43, s4, 54
s_add_u32 s42, s42, s43
s_mul_i32 s50, s42, 5120
s_add_u32 s50, s50, 2621440
s_add_u32 s51, s50, 66560
s_mul_i32 s97, s52, 5120
s_add_u32 s97, s97, s50
s_mul_i32 s44, s3, 7
s_cmp_eq_u32 s3, 3
s_cselect_b32 s45, 1, 0
s_sub_u32 s44, s44, s45
s_lshl_b32 s45, s4, 5
s_add_u32 s44, s44, s45
s_lshl_b32 s44, s44, 6
s_add_u32 s54, s44, 5308416
v_min_u32 v122, 6, v1
v_lshlrev_b32 v122, 6, v122
s_waitcnt vmcnt(23)
ds_read_b64_tr_b16 a[48:49], v8 offset:12288
ds_read_b64_tr_b16 a[50:51], v8 offset:12800
ds_read_b64_tr_b16 a[52:53], v9 offset:12288
ds_read_b64_tr_b16 a[54:55], v9 offset:12800
ds_read_b64_tr_b16 a[56:57], v10 offset:12288
ds_read_b64_tr_b16 a[58:59], v10 offset:12800
ds_read_b64_tr_b16 a[60:61], v11 offset:12288
ds_read_b64_tr_b16 a[62:63], v11 offset:12800
s_waitcnt vmcnt(19)
ds_read_b64_tr_b16 a[64:65], v8 offset:16384
ds_read_b64_tr_b16 a[66:67], v8 offset:16896
ds_read_b64_tr_b16 a[68:69], v9 offset:16384
ds_read_b64_tr_b16 a[70:71], v9 offset:16896
ds_read_b64_tr_b16 a[72:73], v10 offset:16384
ds_read_b64_tr_b16 a[74:75], v10 offset:16896
ds_read_b64_tr_b16 a[76:77], v11 offset:16384
ds_read_b64_tr_b16 a[78:79], v11 offset:16896
s_waitcnt lgkmcnt(8)
buffer_load_dwordx4 v128, s[16:19], s99 offen lds
s_add_u32 m0, s46, 13312
s_nop 0
buffer_load_dwordx4 v129, s[16:19], s99 offen lds
s_add_u32 m0, s46, 14336
s_nop 0
buffer_load_dwordx4 v130, s[16:19], s99 offen lds
s_add_u32 m0, s46, 15360
s_nop 0
buffer_load_dwordx4 v131, s[16:19], s99 offen lds
s_add_u32 m0, s46, 16384
s_add_u32 s99, s99, 131072
s_cmp_eq_u32 s99, s53
s_cselect_b32 s99, s95, s99
s_waitcnt lgkmcnt(0)
buffer_load_dwordx4 v128, s[16:19], s99 offen lds
s_add_u32 m0, s46, 17408
s_nop 0
buffer_load_dwordx4 v129, s[16:19], s99 offen lds
s_add_u32 m0, s46, 18432
s_nop 0
buffer_load_dwordx4 v130, s[16:19], s99 offen lds
s_add_u32 m0, s46, 19456
s_nop 0
buffer_load_dwordx4 v131, s[16:19], s99 offen lds
s_add_u32 m0, s46, 20480
s_add_u32 s99, s99, 131072
s_cmp_eq_u32 s99, s53
s_cselect_b32 s99, s95, s99
s_waitcnt vmcnt(8)
s_barrier
s_lshl_b32 s44, s94, 5
s_add_u32 s44, s44, s5
s_lshl_b32 s44, s44, 6
s_add_u32 s44, s44, 5308416
s_cmp_lg_u32 s3, 0
s_cbranch_scc1 L_flag_g
v_mov_b32 v16, s40
v_mov_b32 v17, s41
v_mov_b32 v18, 0
s_mov_b64 s[100:101], exec
s_mov_b64 exec, 1
buffer_store_dwordx2 v[16:17], v18, s[36:39], s44 offen sc1
s_mov_b64 exec, s[100:101]
s_nop 1
L_flag_g:
buffer_load_dwordx2 v[120:121], v122, s[36:39], s54 offen sc1
ds_read_b64_tr_b16 a[80:81], v8 offset:20480
ds_read_b64_tr_b16 a[82:83], v8 offset:20992
ds_read_b64_tr_b16 a[84:85], v9 offset:20480
ds_read_b64_tr_b16 a[86:87], v9 offset:20992
ds_read_b64_tr_b16 a[88:89], v10 offset:20480
ds_read_b64_tr_b16 a[90:91], v10 offset:20992
ds_read_b64_tr_b16 a[92:93], v11 offset:20480
ds_read_b64_tr_b16 a[94:95], v11 offset:20992
ds_read_b64_tr_b16 a[96:97], v8 offset:0
ds_read_b64_tr_b16 a[98:99], v8 offset:512
ds_read_b64_tr_b16 a[100:101], v9 offset:0
ds_read_b64_tr_b16 a[102:103], v9 offset:512
ds_read_b64_tr_b16 a[104:105], v10 offset:0
ds_read_b64_tr_b16 a[106:107], v10 offset:512
ds_read_b64_tr_b16 a[108:109], v11 offset:0
ds_read_b64_tr_b16 a[110:111], v11 offset:512
s_waitcnt lgkmcnt(8)
buffer_load_dwordx4 v128, s[16:19], s99 offen lds
s_add_u32 m0, s46, 21504
s_nop 0
buffer_load_dwordx4 v129, s[16:19], s99 offen lds
s_add_u32 m0, s46, 22528
s_nop 0
buffer_load_dwordx4 v130, s[16:19], s99 offen lds
s_add_u32 m0, s46, 23552
s_nop 0
buffer_load_dwordx4 v131, s[16:19], s99 offen lds
s_add_u32 m0, s46, 0
s_add_u32 s99, s99, 131072
s_cmp_eq_u32 s99, s53
s_cselect_b32 s99, s95, s99
ds_read_b64_tr_b16 a[112:113], v8 offset:4096
ds_read_b64_tr_b16 a[114:115], v8 offset:4608
ds_read_b64_tr_b16 a[116:117], v9 offset:4096
ds_read_b64_tr_b16 a[118:119], v9 offset:4608
ds_read_b64_tr_b16 a[120:121], v10 offset:4096
ds_read_b64_tr_b16 a[122:123], v10 offset:4608
ds_read_b64_tr_b16 a[124:125], v11 offset:4096
ds_read_b64_tr_b16 a[126:127], v11 offset:4608
s_waitcnt lgkmcnt(8)
buffer_load_dwordx4 v128, s[16:19], s99 offen lds
s_add_u32 m0, s46, 1024
s_nop 0
buffer_load_dwordx4 v129, s[16:19], s99 offen lds
s_add_u32 m0, s46, 2048
s_nop 0
buffer_load_dwordx4 v130, s[16:19], s99 offen lds
s_add_u32 m0, s46, 3072
s_nop 0
buffer_load_dwordx4 v131, s[16:19], s99 offen lds
s_add_u32 m0, s46, 4096
s_add_u32 s99, s99, 131072
s_cmp_eq_u32 s99, s53
s_cselect_b32 s99, s95, s99
s_waitcnt lgkmcnt(0)
s_cmp_ge_u32 s3, 2
s_cbranch_scc1 L_w2_d0
s_add_u32 s47, s95, 1703936
buffer_load_dwordx4 v128, s[16:19], s47 offen lds
s_add_u32 m0, s46, 5120
s_nop 0
buffer_load_dwordx4 v129, s[16:19], s47 offen lds
s_add_u32 m0, s46, 6144
s_nop 0
buffer_load_dwordx4 v130, s[16:19], s47 offen lds
s_add_u32 m0, s46, 7168
s_nop 0
buffer_load_dwordx4 v131, s[16:19], s47 offen lds
L_w2_d0:
s_branch L_gemm2
L_idle:
s_waitcnt vmcnt(0)
s_add_u32 s42, s3, 1
s_and_b32 s42, s42, 3
s_mul_i32 s43, s42, 36864
s_add_u32 s43, s43, 24576
v_add_u32 v137, s43, v2
s_add_u32 s42, s3, 2
s_and_b32 s42, s42, 3
s_mul_i32 s43, s42, 36864
s_add_u32 s43, s43, 24576
v_add_u32 v138, s43, v2
s_add_u32 s42, s3, 3
s_and_b32 s42, s42, 3
s_mul_i32 s43, s42, 36864
s_add_u32 s43, s43, 24576
v_add_u32 v139, s43, v2
s_mul_i32 s43, s42, 3072
s_add_u32 s43, s43, 147456
v_add_u32 v140, s43, v2
s_add_u32 s43, s46, 24576
v_add_u32 v141, s43, v2
s_mul_i32 s43, s3, 3072
s_add_u32 s43, s43, 147456
v_add_u32 v142, s43, v2
v_lshrrev_b32 v12, 4, v1
v_and_b32 v13, 1, v12
v_lshlrev_b32 v133, 10, v13
v_lshlrev_b32 v135, 5, v13
v_lshrrev_b32 v12, 1, v12
v_lshl_add_u32 v134, v12, 8, 0
v_lshlrev_b32 v136, 4, v12
v_and_b32 v12, 15, v1
v_lshl_add_u32 v134, v12, 4, v134
v_add_u32 v133, v133, v134
v_mul_u32_u24 v12, 1280, v12
v_add_u32 v136, v136, v12
v_add_u32 v135, v135, v136
s_mul_i32 s42, s94, 54
s_lshl_b32 s43, s5, 1
s_add_u32 s42, s42, s43
s_lshr_b32 s43, s3, 1
s_add_u32 s42, s42, s43
s_mul_i32 s42, s42, 5120
s_and_b32 s43, s3, 1
s_lshl_b32 s43, s43, 9
s_add_u32 s42, s42, s43
s_add_u32 s54, s42, 2621440
s_lshl_b32 s42, s6, 2
s_add_u32 s42, s42, s3
s_mul_i32 s42, s42, 20480
s_mul_i32 s43, s4, 160
s_add_u32 s55, s42, s43
v_mov_b32 v144, 0xc0135761
v_mov_b32 v145, 0xc0135761
v_mov_b32 v146, 0xbdd2d3e8
v_mov_b32 v147, 0xbdd2d3e8
v_mov_b32 v148, 1.0
v_mov_b32 v149, 1.0
v_lshrrev_b32 v12, 3, v1
v_and_b32 v13, 2, v12
v_mul_u32_u24 v12, 4096, v12
v_and_b32 v130, 7, v1
v_xor_b32 v13, v13, v130
v_lshl_add_u32 v128, v13, 4, v12
v_xor_b32 v13, 4, v13
v_lshl_add_u32 v129, v13, 4, v12
v_add_u32 v129, 32768, v129
v_add_u32 v130, 65536, v128
v_add_u32 v131, 65536, v129
s_mov_b32 s52, 0
s_mul_i32 s42, s3, 14
s_cmp_eq_u32 s3, 3
s_cselect_b32 s45, 1, 0
s_sub_u32 s42, s42, s45
s_mul_i32 s95, s42, 131072
s_lshl_b32 s42, s6, 7
s_add_u32 s95, s95, s42
s_add_u32 s53, s95, 1703936
s_mul_i32 s99, s52, 131072
s_add_u32 s99, s99, s95
s_lshl_b32 s42, s6, 7
s_lshl_b32 s43, s3, 5
s_add_u32 s42, s42, s43
v_and_b32 v12, 15, v1
v_lshlrev_b32 v12, 1, v12
buffer_load_ushort v132, v12, s[24:27], s42 offen
s_lshl_b32 s44, s3, 11
s_add_u32 s54, s44, 5242880
v_lshlrev_b32 v122, 5, v1
s_and_b32 s42, s2, 7
s_and_b32 s43, s2, 1
s_add_u32 s43, s43, 8
s_lshr_b32 s44, s2, 5
s_cmp_eq_u32 s44, 7
s_cselect_b32 s42, s42, s43
s_lshl_b32 s42, s42, 2
s_bfe_u32 s43, s2, 0x20003
s_add_u32 s42, s42, s43
s_lshl_b32 s42, s42, 2
s_add_u32 s56, s42, s3
s_mul_i32 s42, s56, 45056
s_mov_b32 s43, 44
L_pf_loop:
buffer_load_dwordx4 v[20:23], v2, s[16:19], s42 offen
s_add_u32 s42, s42, 1024
s_sub_u32 s43, s43, 1
s_cmp_lg_u32 s43, 0
s_cbranch_scc1 L_pf_loop
s_waitcnt vmcnt(0)
s_add_u32 m0, s46, 0
s_nop 0
buffer_load_dwordx4 v128, s[16:19], s99 offen lds
s_add_u32 m0, s46, 1024
s_nop 0
buffer_load_dwordx4 v129, s[16:19], s99 offen lds
s_add_u32 m0, s46, 2048
s_nop 0
buffer_load_dwordx4 v130, s[16:19], s99 offen lds
s_add_u32 m0, s46, 3072
s_nop 0
buffer_load_dwordx4 v131, s[16:19], s99 offen lds
s_add_u32 m0, s46, 4096
s_add_u32 s99, s99, 131072
s_cmp_eq_u32 s99, s53
s_cselect_b32 s99, s95, s99
buffer_load_dwordx4 v128, s[16:19], s99 offen lds
s_add_u32 m0, s46, 5120
s_nop 0
buffer_load_dwordx4 v129, s[16:19], s99 offen lds
s_add_u32 m0, s46, 6144
s_nop 0
buffer_load_dwordx4 v130, s[16:19], s99 offen lds
s_add_u32 m0, s46, 7168
s_nop 0
buffer_load_dwordx4 v131, s[16:19], s99 offen lds
s_add_u32 m0, s46, 8192
s_add_u32 s99, s99, 131072
s_cmp_eq_u32 s99, s53
s_cselect_b32 s99, s95, s99
buffer_load_dwordx4 v128, s[16:19], s99 offen lds
s_add_u32 m0, s46, 9216
s_nop 0
buffer_load_dwordx4 v129, s[16:19], s99 offen lds
s_add_u32 m0, s46, 10240
s_nop 0
buffer_load_dwordx4 v130, s[16:19], s99 offen lds
s_add_u32 m0, s46, 11264
s_nop 0
buffer_load_dwordx4 v131, s[16:19], s99 offen lds
s_add_u32 m0, s46, 12288
s_add_u32 s99, s99, 131072
s_cmp_eq_u32 s99, s53
s_cselect_b32 s99, s95, s99
buffer_load_dwordx4 v128, s[16:19], s99 offen lds
s_add_u32 m0, s46, 13312
s_nop 0
buffer_load_dwordx4 v129, s[16:19], s99 offen lds
s_add_u32 m0, s46, 14336
s_nop 0
buffer_load_dwordx4 v130, s[16:19], s99 offen lds
s_add_u32 m0, s46, 15360
s_nop 0
buffer_load_dwordx4 v131, s[16:19], s99 offen lds
s_add_u32 m0, s46, 16384
s_add_u32 s99, s99, 131072
s_cmp_eq_u32 s99, s53
s_cselect_b32 s99, s95, s99
buffer_load_dwordx4 v128, s[16:19], s99 offen lds
s_add_u32 m0, s46, 17408
s_nop 0
buffer_load_dwordx4 v129, s[16:19], s99 offen lds
s_add_u32 m0, s46, 18432
s_nop 0
buffer_load_dwordx4 v130, s[16:19], s99 offen lds
s_add_u32 m0, s46, 19456
s_nop 0
buffer_load_dwordx4 v131, s[16:19], s99 offen lds
s_add_u32 m0, s46, 20480
s_add_u32 s99, s99, 131072
s_cmp_eq_u32 s99, s53
s_cselect_b32 s99, s95, s99
buffer_load_dwordx4 v128, s[16:19], s99 offen lds
s_add_u32 m0, s46, 21504
s_nop 0
buffer_load_dwordx4 v129, s[16:19], s99 offen lds
s_add_u32 m0, s46, 22528
s_nop 0
buffer_load_dwordx4 v130, s[16:19], s99 offen lds
s_add_u32 m0, s46, 23552
s_nop 0
buffer_load_dwordx4 v131, s[16:19], s99 offen lds
s_add_u32 m0, s46, 0
s_add_u32 s99, s99, 131072
s_cmp_eq_u32 s99, s53
s_cselect_b32 s99, s95, s99
s_waitcnt vmcnt(20)
ds_read_b64_tr_b16 a[0:1], v8 offset:0
ds_read_b64_tr_b16 a[2:3], v8 offset:512
ds_read_b64_tr_b16 a[4:5], v9 offset:0
ds_read_b64_tr_b16 a[6:7], v9 offset:512
ds_read_b64_tr_b16 a[8:9], v10 offset:0
ds_read_b64_tr_b16 a[10:11], v10 offset:512
ds_read_b64_tr_b16 a[12:13], v11 offset:0
ds_read_b64_tr_b16 a[14:15], v11 offset:512
s_waitcnt vmcnt(16)
ds_read_b64_tr_b16 a[16:17], v8 offset:4096
ds_read_b64_tr_b16 a[18:19], v8 offset:4608
ds_read_b64_tr_b16 a[20:21], v9 offset:4096
ds_read_b64_tr_b16 a[22:23], v9 offset:4608
ds_read_b64_tr_b16 a[24:25], v10 offset:4096
ds_read_b64_tr_b16 a[26:27], v10 offset:4608
ds_read_b64_tr_b16 a[28:29], v11 offset:4096
ds_read_b64_tr_b16 a[30:31], v11 offset:4608
s_waitcnt lgkmcnt(8)
buffer_load_dwordx4 v128, s[16:19], s99 offen lds
s_add_u32 m0, s46, 1024
s_nop 0
buffer_load_dwordx4 v129, s[16:19], s99 offen lds
s_add_u32 m0, s46, 2048
s_nop 0
buffer_load_dwordx4 v130, s[16:19], s99 offen lds
s_add_u32 m0, s46, 3072
s_nop 0
buffer_load_dwordx4 v131, s[16:19], s99 offen lds
s_add_u32 m0, s46, 4096
s_add_u32 s99, s99, 131072
s_cmp_eq_u32 s99, s53
s_cselect_b32 s99, s95, s99
s_waitcnt vmcnt(16)
ds_read_b64_tr_b16 a[32:33], v8 offset:8192
ds_read_b64_tr_b16 a[34:35], v8 offset:8704
ds_read_b64_tr_b16 a[36:37], v9 offset:8192
ds_read_b64_tr_b16 a[38:39], v9 offset:8704
ds_read_b64_tr_b16 a[40:41], v10 offset:8192
ds_read_b64_tr_b16 a[42:43], v10 offset:8704
ds_read_b64_tr_b16 a[44:45], v11 offset:8192
ds_read_b64_tr_b16 a[46:47], v11 offset:8704
s_waitcnt lgkmcnt(8)
buffer_load_dwordx4 v128, s[16:19], s99 offen lds
s_add_u32 m0, s46, 5120
s_nop 0
buffer_load_dwordx4 v129, s[16:19], s99 offen lds
s_add_u32 m0, s46, 6144
s_nop 0
buffer_load_dwordx4 v130, s[16:19], s99 offen lds
s_add_u32 m0, s46, 7168
s_nop 0
buffer_load_dwordx4 v131, s[16:19], s99 offen lds
s_add_u32 m0, s46, 8192
s_add_u32 s99, s99, 131072
s_cmp_eq_u32 s99, s53
s_cselect_b32 s99, s95, s99
s_waitcnt vmcnt(16)
ds_read_b64_tr_b16 a[48:49], v8 offset:12288
ds_read_b64_tr_b16 a[50:51], v8 offset:12800
ds_read_b64_tr_b16 a[52:53], v9 offset:12288
ds_read_b64_tr_b16 a[54:55], v9 offset:12800
ds_read_b64_tr_b16 a[56:57], v10 offset:12288
ds_read_b64_tr_b16 a[58:59], v10 offset:12800
ds_read_b64_tr_b16 a[60:61], v11 offset:12288
ds_read_b64_tr_b16 a[62:63], v11 offset:12800
s_waitcnt lgkmcnt(8)
buffer_load_dwordx4 v128, s[16:19], s99 offen lds
s_add_u32 m0, s46, 9216
s_nop 0
buffer_load_dwordx4 v129, s[16:19], s99 offen lds
s_add_u32 m0, s46, 10240
s_nop 0
buffer_load_dwordx4 v130, s[16:19], s99 offen lds
s_add_u32 m0, s46, 11264
s_nop 0
buffer_load_dwordx4 v131, s[16:19], s99 offen lds
s_add_u32 m0, s46, 12288
s_add_u32 s99, s99, 131072
s_cmp_eq_u32 s99, s53
s_cselect_b32 s99, s95, s99
s_waitcnt vmcnt(16)
ds_read_b64_tr_b16 a[64:65], v8 offset:16384
ds_read_b64_tr_b16 a[66:67], v8 offset:16896
ds_read_b64_tr_b16 a[68:69], v9 offset:16384
ds_read_b64_tr_b16 a[70:71], v9 offset:16896
ds_read_b64_tr_b16 a[72:73], v10 offset:16384
ds_read_b64_tr_b16 a[74:75], v10 offset:16896
ds_read_b64_tr_b16 a[76:77], v11 offset:16384
ds_read_b64_tr_b16 a[78:79], v11 offset:16896
s_waitcnt lgkmcnt(8)
buffer_load_dwordx4 v128, s[16:19], s99 offen lds
s_add_u32 m0, s46, 13312
s_nop 0
buffer_load_dwordx4 v129, s[16:19], s99 offen lds
s_add_u32 m0, s46, 14336
s_nop 0
buffer_load_dwordx4 v130, s[16:19], s99 offen lds
s_add_u32 m0, s46, 15360
s_nop 0
buffer_load_dwordx4 v131, s[16:19], s99 offen lds
s_add_u32 m0, s46, 16384
s_add_u32 s99, s99, 131072
s_cmp_eq_u32 s99, s53
s_cselect_b32 s99, s95, s99
s_waitcnt vmcnt(16)
ds_read_b64_tr_b16 a[80:81], v8 offset:20480
ds_read_b64_tr_b16 a[82:83], v8 offset:20992
ds_read_b64_tr_b16 a[84:85], v9 offset:20480
ds_read_b64_tr_b16 a[86:87], v9 offset:20992
ds_read_b64_tr_b16 a[88:89], v10 offset:20480
ds_read_b64_tr_b16 a[90:91], v10 offset:20992
ds_read_b64_tr_b16 a[92:93], v11 offset:20480
ds_read_b64_tr_b16 a[94:95], v11 offset:20992
s_waitcnt lgkmcnt(8)
buffer_load_dwordx4 v128, s[16:19], s99 offen lds
s_add_u32 m0, s46, 17408
s_nop 0
buffer_load_dwordx4 v129, s[16:19], s99 offen lds
s_add_u32 m0, s46, 18432
s_nop 0
buffer_load_dwordx4 v130, s[16:19], s99 offen lds
s_add_u32 m0, s46, 19456
s_nop 0
buffer_load_dwordx4 v131, s[16:19], s99 offen lds
s_add_u32 m0, s46, 20480
s_add_u32 s99, s99, 131072
s_cmp_eq_u32 s99, s53
s_cselect_b32 s99, s95, s99
s_waitcnt vmcnt(16)
ds_read_b64_tr_b16 a[96:97], v8 offset:0
ds_read_b64_tr_b16 a[98:99], v8 offset:512
ds_read_b64_tr_b16 a[100:101], v9 offset:0
ds_read_b64_tr_b16 a[102:103], v9 offset:512
ds_read_b64_tr_b16 a[104:105], v10 offset:0
ds_read_b64_tr_b16 a[106:107], v10 offset:512
ds_read_b64_tr_b16 a[108:109], v11 offset:0
ds_read_b64_tr_b16 a[110:111], v11 offset:512
s_waitcnt lgkmcnt(8)
buffer_load_dwordx4 v128, s[16:19], s99 offen lds
s_add_u32 m0, s46, 21504
s_nop 0
buffer_load_dwordx4 v129, s[16:19], s99 offen lds
s_add_u32 m0, s46, 22528
s_nop 0
buffer_load_dwordx4 v130, s[16:19], s99 offen lds
s_add_u32 m0, s46, 23552
s_nop 0
buffer_load_dwordx4 v131, s[16:19], s99 offen lds
s_add_u32 m0, s46, 0
s_add_u32 s99, s99, 131072
s_cmp_eq_u32 s99, s53
s_cselect_b32 s99, s95, s99
s_waitcnt vmcnt(16)
ds_read_b64_tr_b16 a[112:113], v8 offset:4096
ds_read_b64_tr_b16 a[114:115], v8 offset:4608
ds_read_b64_tr_b16 a[116:117], v9 offset:4096
ds_read_b64_tr_b16 a[118:119], v9 offset:4608
ds_read_b64_tr_b16 a[120:121], v10 offset:4096
ds_read_b64_tr_b16 a[122:123], v10 offset:4608
ds_read_b64_tr_b16 a[124:125], v11 offset:4096
ds_read_b64_tr_b16 a[126:127], v11 offset:4608
s_waitcnt lgkmcnt(8)
buffer_load_dwordx4 v128, s[16:19], s99 offen lds
s_add_u32 m0, s46, 1024
s_nop 0
buffer_load_dwordx4 v129, s[16:19], s99 offen lds
s_add_u32 m0, s46, 2048
s_nop 0
buffer_load_dwordx4 v130, s[16:19], s99 offen lds
s_add_u32 m0, s46, 3072
s_nop 0
buffer_load_dwordx4 v131, s[16:19], s99 offen lds
s_add_u32 m0, s46, 4096
s_add_u32 s99, s99, 131072
s_cmp_eq_u32 s99, s53
s_cselect_b32 s99, s95, s99
s_waitcnt lgkmcnt(0)
s_cmp_ge_u32 s3, 2
s_cbranch_scc1 L_w2i_d0
s_add_u32 s47, s95, 1703936
buffer_load_dwordx4 v128, s[16:19], s47 offen lds
s_add_u32 m0, s46, 5120
s_nop 0
buffer_load_dwordx4 v129, s[16:19], s47 offen lds
s_add_u32 m0, s46, 6144
s_nop 0
buffer_load_dwordx4 v130, s[16:19], s47 offen lds
s_add_u32 m0, s46, 7168
s_nop 0
buffer_load_dwordx4 v131, s[16:19], s47 offen lds
L_w2i_d0:
s_mov_b32 s52, 0
s_mul_i32 s42, s3, 14
s_cmp_eq_u32 s3, 3
s_cselect_b32 s45, 1, 0
s_sub_u32 s42, s42, s45
s_mul_i32 s43, s4, 54
s_add_u32 s42, s42, s43
s_mul_i32 s50, s42, 5120
s_add_u32 s50, s50, 2621440
s_add_u32 s51, s50, 66560
s_mul_i32 s97, s52, 5120
s_add_u32 s97, s97, s50
s_mul_i32 s44, s3, 7
s_cmp_eq_u32 s3, 3
s_cselect_b32 s45, 1, 0
s_sub_u32 s44, s44, s45
s_lshl_b32 s45, s4, 5
s_add_u32 s44, s44, s45
s_lshl_b32 s44, s44, 6
s_add_u32 s54, s44, 5308416
v_min_u32 v122, 6, v1
v_lshlrev_b32 v122, 6, v122
buffer_load_dwordx2 v[120:121], v122, s[36:39], s54 offen sc1
s_waitcnt vmcnt(0)
L_gemm2:
s_waitcnt vmcnt(8)
s_mov_b32 s98, 200000
L_poll_g:
v_cmp_ne_u32 vcc, s40, v120
v_cmp_ne_u32 s[42:43], s41, v121
s_nop 3
s_or_b64 vcc, vcc, s[42:43]
s_cbranch_vccz L_poll_g_ok
s_sleep 1
buffer_load_dwordx2 v[120:121], v122, s[36:39], s54 offen sc1
s_waitcnt vmcnt(0)
s_sub_u32 s98, s98, 1
s_cbranch_scc0 L_poll_g
L_poll_g_ok:
buffer_load_dwordx4 v[16:19], v2, s[36:39], s97 offen offset:0 sc1
buffer_load_dwordx4 v[20:23], v2, s[36:39], s97 offen offset:1024 sc1
buffer_load_dwordx4 v[24:27], v2, s[36:39], s97 offen offset:2048 sc1
buffer_load_dwordx4 v[28:31], v2, s[36:39], s97 offen offset:3072 sc1
buffer_load_dwordx4 v[32:35], v3, s[36:39], s97 offen sc1
s_add_u32 s97, s97, 5120
s_cmp_eq_u32 s97, s51
s_cselect_b32 s97, s50, s97
buffer_load_dwordx4 v[36:39], v2, s[36:39], s97 offen offset:0 sc1
buffer_load_dwordx4 v[40:43], v2, s[36:39], s97 offen offset:1024 sc1
buffer_load_dwordx4 v[44:47], v2, s[36:39], s97 offen offset:2048 sc1
buffer_load_dwordx4 v[48:51], v2, s[36:39], s97 offen offset:3072 sc1
buffer_load_dwordx4 v[52:55], v3, s[36:39], s97 offen sc1
s_add_u32 s97, s97, 5120
s_cmp_eq_u32 s97, s51
s_cselect_b32 s97, s50, s97
buffer_load_dwordx4 v[56:59], v2, s[36:39], s97 offen offset:0 sc1
buffer_load_dwordx4 v[60:63], v2, s[36:39], s97 offen offset:1024 sc1
buffer_load_dwordx4 v[64:67], v2, s[36:39], s97 offen offset:2048 sc1
buffer_load_dwordx4 v[68:71], v2, s[36:39], s97 offen offset:3072 sc1
buffer_load_dwordx4 v[72:75], v3, s[36:39], s97 offen sc1
s_add_u32 s97, s97, 5120
s_cmp_eq_u32 s97, s51
s_cselect_b32 s97, s50, s97
buffer_load_dwordx4 v[76:79], v2, s[36:39], s97 offen offset:0 sc1
buffer_load_dwordx4 v[80:83], v2, s[36:39], s97 offen offset:1024 sc1
buffer_load_dwordx4 v[84:87], v2, s[36:39], s97 offen offset:2048 sc1
buffer_load_dwordx4 v[88:91], v2, s[36:39], s97 offen offset:3072 sc1
buffer_load_dwordx4 v[92:95], v3, s[36:39], s97 offen sc1
s_add_u32 s97, s97, 5120
s_cmp_eq_u32 s97, s51
s_cselect_b32 s97, s50, s97
v_lshlrev_b32 v160, 16, v132
v_mov_b32 v161, v160
v_mov_b32 v162, v160
v_mov_b32 v163, v160
s_waitcnt vmcnt(15)
s_waitcnt lgkmcnt(0)
v_mfma_f32_16x16x32_bf16 v[176:179], v[16:19], a[0:3], v[160:163]
v_mfma_f32_16x16x32_bf16 v[196:199], v[16:19], a[4:7], 0
v_mfma_f32_16x16x32_bf16 v[216:219], v[16:19], a[8:11], 0
v_mfma_f32_16x16x32_bf16 v[236:239], v[16:19], a[12:15], 0
buffer_load_dwordx4 v[16:19], v2, s[36:39], s97 offen offset:0 sc1
v_mfma_f32_16x16x32_bf16 v[180:183], v[20:23], a[0:3], v[160:163]
v_mfma_f32_16x16x32_bf16 v[200:203], v[20:23], a[4:7], 0
v_mfma_f32_16x16x32_bf16 v[220:223], v[20:23], a[8:11], 0
v_mfma_f32_16x16x32_bf16 v[240:243], v[20:23], a[12:15], 0
buffer_load_dwordx4 v[20:23], v2, s[36:39], s97 offen offset:1024 sc1
v_mfma_f32_16x16x32_bf16 v[184:187], v[24:27], a[0:3], v[160:163]
v_mfma_f32_16x16x32_bf16 v[204:207], v[24:27], a[4:7], 0
v_mfma_f32_16x16x32_bf16 v[224:227], v[24:27], a[8:11], 0
v_mfma_f32_16x16x32_bf16 v[244:247], v[24:27], a[12:15], 0
buffer_load_dwordx4 v[24:27], v2, s[36:39], s97 offen offset:2048 sc1
v_mfma_f32_16x16x32_bf16 v[188:191], v[28:31], a[0:3], v[160:163]
v_mfma_f32_16x16x32_bf16 v[208:211], v[28:31], a[4:7], 0
v_mfma_f32_16x16x32_bf16 v[228:231], v[28:31], a[8:11], 0
v_mfma_f32_16x16x32_bf16 v[248:251], v[28:31], a[12:15], 0
buffer_load_dwordx4 v[28:31], v2, s[36:39], s97 offen offset:3072 sc1
v_mfma_f32_16x16x32_bf16 v[192:195], v[32:35], a[0:3], v[160:163]
v_mfma_f32_16x16x32_bf16 v[212:215], v[32:35], a[4:7], 0
v_mfma_f32_16x16x32_bf16 v[232:235], v[32:35], a[8:11], 0
v_mfma_f32_16x16x32_bf16 v[252:255], v[32:35], a[12:15], 0
buffer_load_dwordx4 v[32:35], v3, s[36:39], s97 offen sc1
s_add_u32 s97, s97, 5120
s_cmp_eq_u32 s97, s51
s_cselect_b32 s97, s50, s97
s_waitcnt vmcnt(15)
v_mfma_f32_16x16x32_bf16 v[176:179], v[36:39], a[16:19], v[176:179]
v_mfma_f32_16x16x32_bf16 v[196:199], v[36:39], a[20:23], v[196:199]
v_mfma_f32_16x16x32_bf16 v[216:219], v[36:39], a[24:27], v[216:219]
v_mfma_f32_16x16x32_bf16 v[236:239], v[36:39], a[28:31], v[236:239]
buffer_load_dwordx4 v[36:39], v2, s[36:39], s97 offen offset:0 sc1
v_mfma_f32_16x16x32_bf16 v[180:183], v[40:43], a[16:19], v[180:183]
v_mfma_f32_16x16x32_bf16 v[200:203], v[40:43], a[20:23], v[200:203]
v_mfma_f32_16x16x32_bf16 v[220:223], v[40:43], a[24:27], v[220:223]
v_mfma_f32_16x16x32_bf16 v[240:243], v[40:43], a[28:31], v[240:243]
buffer_load_dwordx4 v[40:43], v2, s[36:39], s97 offen offset:1024 sc1
v_mfma_f32_16x16x32_bf16 v[184:187], v[44:47], a[16:19], v[184:187]
v_mfma_f32_16x16x32_bf16 v[204:207], v[44:47], a[20:23], v[204:207]
v_mfma_f32_16x16x32_bf16 v[224:227], v[44:47], a[24:27], v[224:227]
v_mfma_f32_16x16x32_bf16 v[244:247], v[44:47], a[28:31], v[244:247]
buffer_load_dwordx4 v[44:47], v2, s[36:39], s97 offen offset:2048 sc1
v_mfma_f32_16x16x32_bf16 v[188:191], v[48:51], a[16:19], v[188:191]
v_mfma_f32_16x16x32_bf16 v[208:211], v[48:51], a[20:23], v[208:211]
v_mfma_f32_16x16x32_bf16 v[228:231], v[48:51], a[24:27], v[228:231]
v_mfma_f32_16x16x32_bf16 v[248:251], v[48:51], a[28:31], v[248:251]
buffer_load_dwordx4 v[48:51], v2, s[36:39], s97 offen offset:3072 sc1
v_mfma_f32_16x16x32_bf16 v[192:195], v[52:55], a[16:19], v[192:195]
v_mfma_f32_16x16x32_bf16 v[212:215], v[52:55], a[20:23], v[212:215]
v_mfma_f32_16x16x32_bf16 v[232:235], v[52:55], a[24:27], v[232:235]
v_mfma_f32_16x16x32_bf16 v[252:255], v[52:55], a[28:31], v[252:255]
buffer_load_dwordx4 v[52:55], v3, s[36:39], s97 offen sc1
s_add_u32 s97, s97, 5120
s_cmp_eq_u32 s97, s51
s_cselect_b32 s97, s50, s97
s_waitcnt vmcnt(15)
v_mfma_f32_16x16x32_bf16 v[176:179], v[56:59], a[32:35], v[176:179]
v_mfma_f32_16x16x32_bf16 v[196:199], v[56:59], a[36:39], v[196:199]
v_mfma_f32_16x16x32_bf16 v[216:219], v[56:59], a[40:43], v[216:219]
v_mfma_f32_16x16x32_bf16 v[236:239], v[56:59], a[44:47], v[236:239]
buffer_load_dwordx4 v[56:59], v2, s[36:39], s97 offen offset:0 sc1
v_mfma_f32_16x16x32_bf16 v[180:183], v[60:63], a[32:35], v[180:183]
v_mfma_f32_16x16x32_bf16 v[200:203], v[60:63], a[36:39], v[200:203]
v_mfma_f32_16x16x32_bf16 v[220:223], v[60:63], a[40:43], v[220:223]
v_mfma_f32_16x16x32_bf16 v[240:243], v[60:63], a[44:47], v[240:243]
buffer_load_dwordx4 v[60:63], v2, s[36:39], s97 offen offset:1024 sc1
v_mfma_f32_16x16x32_bf16 v[184:187], v[64:67], a[32:35], v[184:187]
v_mfma_f32_16x16x32_bf16 v[204:207], v[64:67], a[36:39], v[204:207]
v_mfma_f32_16x16x32_bf16 v[224:227], v[64:67], a[40:43], v[224:227]
v_mfma_f32_16x16x32_bf16 v[244:247], v[64:67], a[44:47], v[244:247]
buffer_load_dwordx4 v[64:67], v2, s[36:39], s97 offen offset:2048 sc1
v_mfma_f32_16x16x32_bf16 v[188:191], v[68:71], a[32:35], v[188:191]
v_mfma_f32_16x16x32_bf16 v[208:211], v[68:71], a[36:39], v[208:211]
v_mfma_f32_16x16x32_bf16 v[228:231], v[68:71], a[40:43], v[228:231]
v_mfma_f32_16x16x32_bf16 v[248:251], v[68:71], a[44:47], v[248:251]
buffer_load_dwordx4 v[68:71], v2, s[36:39], s97 offen offset:3072 sc1
v_mfma_f32_16x16x32_bf16 v[192:195], v[72:75], a[32:35], v[192:195]
v_mfma_f32_16x16x32_bf16 v[212:215], v[72:75], a[36:39], v[212:215]
v_mfma_f32_16x16x32_bf16 v[232:235], v[72:75], a[40:43], v[232:235]
v_mfma_f32_16x16x32_bf16 v[252:255], v[72:75], a[44:47], v[252:255]
buffer_load_dwordx4 v[72:75], v3, s[36:39], s97 offen sc1
s_add_u32 s97, s97, 5120
s_cmp_eq_u32 s97, s51
s_cselect_b32 s97, s50, s97
s_waitcnt vmcnt(15)
v_mfma_f32_16x16x32_bf16 v[176:179], v[76:79], a[48:51], v[176:179]
v_mfma_f32_16x16x32_bf16 v[196:199], v[76:79], a[52:55], v[196:199]
v_mfma_f32_16x16x32_bf16 v[216:219], v[76:79], a[56:59], v[216:219]
v_mfma_f32_16x16x32_bf16 v[236:239], v[76:79], a[60:63], v[236:239]
buffer_load_dwordx4 v[76:79], v2, s[36:39], s97 offen offset:0 sc1
v_mfma_f32_16x16x32_bf16 v[180:183], v[80:83], a[48:51], v[180:183]
v_mfma_f32_16x16x32_bf16 v[200:203], v[80:83], a[52:55], v[200:203]
v_mfma_f32_16x16x32_bf16 v[220:223], v[80:83], a[56:59], v[220:223]
v_mfma_f32_16x16x32_bf16 v[240:243], v[80:83], a[60:63], v[240:243]
buffer_load_dwordx4 v[80:83], v2, s[36:39], s97 offen offset:1024 sc1
v_mfma_f32_16x16x32_bf16 v[184:187], v[84:87], a[48:51], v[184:187]
v_mfma_f32_16x16x32_bf16 v[204:207], v[84:87], a[52:55], v[204:207]
v_mfma_f32_16x16x32_bf16 v[224:227], v[84:87], a[56:59], v[224:227]
v_mfma_f32_16x16x32_bf16 v[244:247], v[84:87], a[60:63], v[244:247]
buffer_load_dwordx4 v[84:87], v2, s[36:39], s97 offen offset:2048 sc1
v_mfma_f32_16x16x32_bf16 v[188:191], v[88:91], a[48:51], v[188:191]
v_mfma_f32_16x16x32_bf16 v[208:211], v[88:91], a[52:55], v[208:211]
v_mfma_f32_16x16x32_bf16 v[228:231], v[88:91], a[56:59], v[228:231]
v_mfma_f32_16x16x32_bf16 v[248:251], v[88:91], a[60:63], v[248:251]
buffer_load_dwordx4 v[88:91], v2, s[36:39], s97 offen offset:3072 sc1
v_mfma_f32_16x16x32_bf16 v[192:195], v[92:95], a[48:51], v[192:195]
v_mfma_f32_16x16x32_bf16 v[212:215], v[92:95], a[52:55], v[212:215]
v_mfma_f32_16x16x32_bf16 v[232:235], v[92:95], a[56:59], v[232:235]
v_mfma_f32_16x16x32_bf16 v[252:255], v[92:95], a[60:63], v[252:255]
buffer_load_dwordx4 v[92:95], v3, s[36:39], s97 offen sc1
s_add_u32 s97, s97, 5120
s_cmp_eq_u32 s97, s51
s_cselect_b32 s97, s50, s97
s_waitcnt vmcnt(15)
v_mfma_f32_16x16x32_bf16 v[176:179], v[16:19], a[64:67], v[176:179]
v_mfma_f32_16x16x32_bf16 v[196:199], v[16:19], a[68:71], v[196:199]
v_mfma_f32_16x16x32_bf16 v[216:219], v[16:19], a[72:75], v[216:219]
v_mfma_f32_16x16x32_bf16 v[236:239], v[16:19], a[76:79], v[236:239]
buffer_load_dwordx4 v[16:19], v2, s[36:39], s97 offen offset:0 sc1
v_mfma_f32_16x16x32_bf16 v[180:183], v[20:23], a[64:67], v[180:183]
v_mfma_f32_16x16x32_bf16 v[200:203], v[20:23], a[68:71], v[200:203]
v_mfma_f32_16x16x32_bf16 v[220:223], v[20:23], a[72:75], v[220:223]
v_mfma_f32_16x16x32_bf16 v[240:243], v[20:23], a[76:79], v[240:243]
buffer_load_dwordx4 v[20:23], v2, s[36:39], s97 offen offset:1024 sc1
v_mfma_f32_16x16x32_bf16 v[184:187], v[24:27], a[64:67], v[184:187]
v_mfma_f32_16x16x32_bf16 v[204:207], v[24:27], a[68:71], v[204:207]
v_mfma_f32_16x16x32_bf16 v[224:227], v[24:27], a[72:75], v[224:227]
v_mfma_f32_16x16x32_bf16 v[244:247], v[24:27], a[76:79], v[244:247]
buffer_load_dwordx4 v[24:27], v2, s[36:39], s97 offen offset:2048 sc1
v_mfma_f32_16x16x32_bf16 v[188:191], v[28:31], a[64:67], v[188:191]
v_mfma_f32_16x16x32_bf16 v[208:211], v[28:31], a[68:71], v[208:211]
v_mfma_f32_16x16x32_bf16 v[228:231], v[28:31], a[72:75], v[228:231]
v_mfma_f32_16x16x32_bf16 v[248:251], v[28:31], a[76:79], v[248:251]
buffer_load_dwordx4 v[28:31], v2, s[36:39], s97 offen offset:3072 sc1
v_mfma_f32_16x16x32_bf16 v[192:195], v[32:35], a[64:67], v[192:195]
v_mfma_f32_16x16x32_bf16 v[212:215], v[32:35], a[68:71], v[212:215]
v_mfma_f32_16x16x32_bf16 v[232:235], v[32:35], a[72:75], v[232:235]
v_mfma_f32_16x16x32_bf16 v[252:255], v[32:35], a[76:79], v[252:255]
buffer_load_dwordx4 v[32:35], v3, s[36:39], s97 offen sc1
s_add_u32 s97, s97, 5120
s_cmp_eq_u32 s97, s51
s_cselect_b32 s97, s50, s97
s_waitcnt vmcnt(15)
v_mfma_f32_16x16x32_bf16 v[176:179], v[36:39], a[80:83], v[176:179]
v_mfma_f32_16x16x32_bf16 v[196:199], v[36:39], a[84:87], v[196:199]
v_mfma_f32_16x16x32_bf16 v[216:219], v[36:39], a[88:91], v[216:219]
v_mfma_f32_16x16x32_bf16 v[236:239], v[36:39], a[92:95], v[236:239]
buffer_load_dwordx4 v[36:39], v2, s[36:39], s97 offen offset:0 sc1
v_mfma_f32_16x16x32_bf16 v[180:183], v[40:43], a[80:83], v[180:183]
v_mfma_f32_16x16x32_bf16 v[200:203], v[40:43], a[84:87], v[200:203]
v_mfma_f32_16x16x32_bf16 v[220:223], v[40:43], a[88:91], v[220:223]
v_mfma_f32_16x16x32_bf16 v[240:243], v[40:43], a[92:95], v[240:243]
buffer_load_dwordx4 v[40:43], v2, s[36:39], s97 offen offset:1024 sc1
v_mfma_f32_16x16x32_bf16 v[184:187], v[44:47], a[80:83], v[184:187]
v_mfma_f32_16x16x32_bf16 v[204:207], v[44:47], a[84:87], v[204:207]
v_mfma_f32_16x16x32_bf16 v[224:227], v[44:47], a[88:91], v[224:227]
v_mfma_f32_16x16x32_bf16 v[244:247], v[44:47], a[92:95], v[244:247]
buffer_load_dwordx4 v[44:47], v2, s[36:39], s97 offen offset:2048 sc1
v_mfma_f32_16x16x32_bf16 v[188:191], v[48:51], a[80:83], v[188:191]
v_mfma_f32_16x16x32_bf16 v[208:211], v[48:51], a[84:87], v[208:211]
v_mfma_f32_16x16x32_bf16 v[228:231], v[48:51], a[88:91], v[228:231]
v_mfma_f32_16x16x32_bf16 v[248:251], v[48:51], a[92:95], v[248:251]
buffer_load_dwordx4 v[48:51], v2, s[36:39], s97 offen offset:3072 sc1
v_mfma_f32_16x16x32_bf16 v[192:195], v[52:55], a[80:83], v[192:195]
v_mfma_f32_16x16x32_bf16 v[212:215], v[52:55], a[84:87], v[212:215]
v_mfma_f32_16x16x32_bf16 v[232:235], v[52:55], a[88:91], v[232:235]
v_mfma_f32_16x16x32_bf16 v[252:255], v[52:55], a[92:95], v[252:255]
buffer_load_dwordx4 v[52:55], v3, s[36:39], s97 offen sc1
s_add_u32 s97, s97, 5120
s_cmp_eq_u32 s97, s51
s_cselect_b32 s97, s50, s97
s_waitcnt vmcnt(15)
v_mfma_f32_16x16x32_bf16 v[176:179], v[56:59], a[96:99], v[176:179]
v_mfma_f32_16x16x32_bf16 v[196:199], v[56:59], a[100:103], v[196:199]
v_mfma_f32_16x16x32_bf16 v[216:219], v[56:59], a[104:107], v[216:219]
v_mfma_f32_16x16x32_bf16 v[236:239], v[56:59], a[108:111], v[236:239]
buffer_load_dwordx4 v[56:59], v2, s[36:39], s97 offen offset:0 sc1
v_mfma_f32_16x16x32_bf16 v[180:183], v[60:63], a[96:99], v[180:183]
v_mfma_f32_16x16x32_bf16 v[200:203], v[60:63], a[100:103], v[200:203]
v_mfma_f32_16x16x32_bf16 v[220:223], v[60:63], a[104:107], v[220:223]
v_mfma_f32_16x16x32_bf16 v[240:243], v[60:63], a[108:111], v[240:243]
buffer_load_dwordx4 v[60:63], v2, s[36:39], s97 offen offset:1024 sc1
v_mfma_f32_16x16x32_bf16 v[184:187], v[64:67], a[96:99], v[184:187]
v_mfma_f32_16x16x32_bf16 v[204:207], v[64:67], a[100:103], v[204:207]
v_mfma_f32_16x16x32_bf16 v[224:227], v[64:67], a[104:107], v[224:227]
v_mfma_f32_16x16x32_bf16 v[244:247], v[64:67], a[108:111], v[244:247]
buffer_load_dwordx4 v[64:67], v2, s[36:39], s97 offen offset:2048 sc1
v_mfma_f32_16x16x32_bf16 v[188:191], v[68:71], a[96:99], v[188:191]
v_mfma_f32_16x16x32_bf16 v[208:211], v[68:71], a[100:103], v[208:211]
v_mfma_f32_16x16x32_bf16 v[228:231], v[68:71], a[104:107], v[228:231]
v_mfma_f32_16x16x32_bf16 v[248:251], v[68:71], a[108:111], v[248:251]
buffer_load_dwordx4 v[68:71], v2, s[36:39], s97 offen offset:3072 sc1
v_mfma_f32_16x16x32_bf16 v[192:195], v[72:75], a[96:99], v[192:195]
v_mfma_f32_16x16x32_bf16 v[212:215], v[72:75], a[100:103], v[212:215]
v_mfma_f32_16x16x32_bf16 v[232:235], v[72:75], a[104:107], v[232:235]
v_mfma_f32_16x16x32_bf16 v[252:255], v[72:75], a[108:111], v[252:255]
buffer_load_dwordx4 v[72:75], v3, s[36:39], s97 offen sc1
s_add_u32 s97, s97, 5120
s_cmp_eq_u32 s97, s51
s_cselect_b32 s97, s50, s97
s_waitcnt vmcnt(15)
v_mfma_f32_16x16x32_bf16 v[176:179], v[76:79], a[112:115], v[176:179]
ds_read_b64_tr_b16 a[128:129], v8 offset:8192
v_mfma_f32_16x16x32_bf16 v[196:199], v[76:79], a[116:119], v[196:199]
ds_read_b64_tr_b16 a[130:131], v8 offset:8704
v_mfma_f32_16x16x32_bf16 v[216:219], v[76:79], a[120:123], v[216:219]
ds_read_b64_tr_b16 a[132:133], v9 offset:8192
v_mfma_f32_16x16x32_bf16 v[236:239], v[76:79], a[124:127], v[236:239]
ds_read_b64_tr_b16 a[134:135], v9 offset:8704
buffer_load_dwordx4 v[76:79], v2, s[36:39], s97 offen offset:0 sc1
v_mfma_f32_16x16x32_bf16 v[180:183], v[80:83], a[112:115], v[180:183]
ds_read_b64_tr_b16 a[136:137], v10 offset:8192
v_mfma_f32_16x16x32_bf16 v[200:203], v[80:83], a[116:119], v[200:203]
ds_read_b64_tr_b16 a[138:139], v10 offset:8704
v_mfma_f32_16x16x32_bf16 v[220:223], v[80:83], a[120:123], v[220:223]
ds_read_b64_tr_b16 a[140:141], v11 offset:8192
v_mfma_f32_16x16x32_bf16 v[240:243], v[80:83], a[124:127], v[240:243]
ds_read_b64_tr_b16 a[142:143], v11 offset:8704
buffer_load_dwordx4 v[80:83], v2, s[36:39], s97 offen offset:1024 sc1
v_mfma_f32_16x16x32_bf16 v[184:187], v[84:87], a[112:115], v[184:187]
v_mfma_f32_16x16x32_bf16 v[204:207], v[84:87], a[116:119], v[204:207]
v_mfma_f32_16x16x32_bf16 v[224:227], v[84:87], a[120:123], v[224:227]
v_mfma_f32_16x16x32_bf16 v[244:247], v[84:87], a[124:127], v[244:247]
buffer_load_dwordx4 v[84:87], v2, s[36:39], s97 offen offset:2048 sc1
v_mfma_f32_16x16x32_bf16 v[188:191], v[88:91], a[112:115], v[188:191]
v_mfma_f32_16x16x32_bf16 v[208:211], v[88:91], a[116:119], v[208:211]
v_mfma_f32_16x16x32_bf16 v[228:231], v[88:91], a[120:123], v[228:231]
v_mfma_f32_16x16x32_bf16 v[248:251], v[88:91], a[124:127], v[248:251]
buffer_load_dwordx4 v[88:91], v2, s[36:39], s97 offen offset:3072 sc1
v_mfma_f32_16x16x32_bf16 v[192:195], v[92:95], a[112:115], v[192:195]
v_mfma_f32_16x16x32_bf16 v[212:215], v[92:95], a[116:119], v[212:215]
v_mfma_f32_16x16x32_bf16 v[232:235], v[92:95], a[120:123], v[232:235]
v_mfma_f32_16x16x32_bf16 v[252:255], v[92:95], a[124:127], v[252:255]
buffer_load_dwordx4 v[92:95], v3, s[36:39], s97 offen sc1
s_add_u32 s97, s97, 5120
s_cmp_eq_u32 s97, s51
s_cselect_b32 s97, s50, s97
s_waitcnt vmcnt(15)
s_waitcnt lgkmcnt(0)
v_mfma_f32_16x16x32_bf16 v[176:179], v[16:19], a[128:131], v[176:179]
ds_read_b64_tr_b16 a[144:145], v8 offset:12288
v_mfma_f32_16x16x32_bf16 v[196:199], v[16:19], a[132:135], v[196:199]
ds_read_b64_tr_b16 a[146:147], v8 offset:12800
v_mfma_f32_16x16x32_bf16 v[216:219], v[16:19], a[136:139], v[216:219]
ds_read_b64_tr_b16 a[148:149], v9 offset:12288
v_mfma_f32_16x16x32_bf16 v[236:239], v[16:19], a[140:143], v[236:239]
ds_read_b64_tr_b16 a[150:151], v9 offset:12800
buffer_load_dwordx4 v[16:19], v2, s[36:39], s97 offen offset:0 sc1
v_mfma_f32_16x16x32_bf16 v[180:183], v[20:23], a[128:131], v[180:183]
ds_read_b64_tr_b16 a[152:153], v10 offset:12288
v_mfma_f32_16x16x32_bf16 v[200:203], v[20:23], a[132:135], v[200:203]
ds_read_b64_tr_b16 a[154:155], v10 offset:12800
v_mfma_f32_16x16x32_bf16 v[220:223], v[20:23], a[136:139], v[220:223]
ds_read_b64_tr_b16 a[156:157], v11 offset:12288
v_mfma_f32_16x16x32_bf16 v[240:243], v[20:23], a[140:143], v[240:243]
ds_read_b64_tr_b16 a[158:159], v11 offset:12800
buffer_load_dwordx4 v[20:23], v2, s[36:39], s97 offen offset:1024 sc1
v_mfma_f32_16x16x32_bf16 v[184:187], v[24:27], a[128:131], v[184:187]
v_mfma_f32_16x16x32_bf16 v[204:207], v[24:27], a[132:135], v[204:207]
v_mfma_f32_16x16x32_bf16 v[224:227], v[24:27], a[136:139], v[224:227]
v_mfma_f32_16x16x32_bf16 v[244:247], v[24:27], a[140:143], v[244:247]
buffer_load_dwordx4 v[24:27], v2, s[36:39], s97 offen offset:2048 sc1
v_mfma_f32_16x16x32_bf16 v[188:191], v[28:31], a[128:131], v[188:191]
v_mfma_f32_16x16x32_bf16 v[208:211], v[28:31], a[132:135], v[208:211]
v_mfma_f32_16x16x32_bf16 v[228:231], v[28:31], a[136:139], v[228:231]
v_mfma_f32_16x16x32_bf16 v[248:251], v[28:31], a[140:143], v[248:251]
buffer_load_dwordx4 v[28:31], v2, s[36:39], s97 offen offset:3072 sc1
v_mfma_f32_16x16x32_bf16 v[192:195], v[32:35], a[128:131], v[192:195]
v_mfma_f32_16x16x32_bf16 v[212:215], v[32:35], a[132:135], v[212:215]
v_mfma_f32_16x16x32_bf16 v[232:235], v[32:35], a[136:139], v[232:235]
v_mfma_f32_16x16x32_bf16 v[252:255], v[32:35], a[140:143], v[252:255]
buffer_load_dwordx4 v[32:35], v3, s[36:39], s97 offen sc1
s_add_u32 s97, s97, 5120
s_cmp_eq_u32 s97, s51
s_cselect_b32 s97, s50, s97
s_waitcnt vmcnt(15)
s_waitcnt lgkmcnt(0)
v_mfma_f32_16x16x32_bf16 v[176:179], v[36:39], a[144:147], v[176:179]
ds_read_b64_tr_b16 a[160:161], v8 offset:16384
v_mfma_f32_16x16x32_bf16 v[196:199], v[36:39], a[148:151], v[196:199]
ds_read_b64_tr_b16 a[162:163], v8 offset:16896
v_mfma_f32_16x16x32_bf16 v[216:219], v[36:39], a[152:155], v[216:219]
ds_read_b64_tr_b16 a[164:165], v9 offset:16384
v_mfma_f32_16x16x32_bf16 v[236:239], v[36:39], a[156:159], v[236:239]
ds_read_b64_tr_b16 a[166:167], v9 offset:16896
v_mfma_f32_16x16x32_bf16 v[180:183], v[40:43], a[144:147], v[180:183]
ds_read_b64_tr_b16 a[168:169], v10 offset:16384
v_mfma_f32_16x16x32_bf16 v[200:203], v[40:43], a[148:151], v[200:203]
ds_read_b64_tr_b16 a[170:171], v10 offset:16896
v_mfma_f32_16x16x32_bf16 v[220:223], v[40:43], a[152:155], v[220:223]
ds_read_b64_tr_b16 a[172:173], v11 offset:16384
v_mfma_f32_16x16x32_bf16 v[240:243], v[40:43], a[156:159], v[240:243]
ds_read_b64_tr_b16 a[174:175], v11 offset:16896
v_mfma_f32_16x16x32_bf16 v[184:187], v[44:47], a[144:147], v[184:187]
v_mfma_f32_16x16x32_bf16 v[204:207], v[44:47], a[148:151], v[204:207]
v_mfma_f32_16x16x32_bf16 v[224:227], v[44:47], a[152:155], v[224:227]
v_mfma_f32_16x16x32_bf16 v[244:247], v[44:47], a[156:159], v[244:247]
v_mfma_f32_16x16x32_bf16 v[188:191], v[48:51], a[144:147], v[188:191]
v_mfma_f32_16x16x32_bf16 v[208:211], v[48:51], a[148:151], v[208:211]
v_mfma_f32_16x16x32_bf16 v[228:231], v[48:51], a[152:155], v[228:231]
v_mfma_f32_16x16x32_bf16 v[248:251], v[48:51], a[156:159], v[248:251]
v_mfma_f32_16x16x32_bf16 v[192:195], v[52:55], a[144:147], v[192:195]
v_mfma_f32_16x16x32_bf16 v[212:215], v[52:55], a[148:151], v[212:215]
v_mfma_f32_16x16x32_bf16 v[232:235], v[52:55], a[152:155], v[232:235]
v_mfma_f32_16x16x32_bf16 v[252:255], v[52:55], a[156:159], v[252:255]
s_cmp_ge_u32 s3, 2
s_cbranch_scc1 L_g2_ld
s_add_u32 s47, s50, 66560
buffer_load_dwordx4 v[36:39], v2, s[36:39], s47 offen offset:0 sc1
buffer_load_dwordx4 v[40:43], v2, s[36:39], s47 offen offset:1024 sc1
buffer_load_dwordx4 v[44:47], v2, s[36:39], s47 offen offset:2048 sc1
buffer_load_dwordx4 v[48:51], v2, s[36:39], s47 offen offset:3072 sc1
buffer_load_dwordx4 v[52:55], v3, s[36:39], s47 offen sc1
L_g2_ld:
s_waitcnt vmcnt(10)
s_waitcnt lgkmcnt(0)
v_mfma_f32_16x16x32_bf16 v[176:179], v[56:59], a[160:163], v[176:179]
ds_read_b64_tr_b16 a[176:177], v8 offset:20480
v_mfma_f32_16x16x32_bf16 v[196:199], v[56:59], a[164:167], v[196:199]
ds_read_b64_tr_b16 a[178:179], v8 offset:20992
v_mfma_f32_16x16x32_bf16 v[216:219], v[56:59], a[168:171], v[216:219]
ds_read_b64_tr_b16 a[180:181], v9 offset:20480
v_mfma_f32_16x16x32_bf16 v[236:239], v[56:59], a[172:175], v[236:239]
ds_read_b64_tr_b16 a[182:183], v9 offset:20992
v_mfma_f32_16x16x32_bf16 v[180:183], v[60:63], a[160:163], v[180:183]
ds_read_b64_tr_b16 a[184:185], v10 offset:20480
v_mfma_f32_16x16x32_bf16 v[200:203], v[60:63], a[164:167], v[200:203]
ds_read_b64_tr_b16 a[186:187], v10 offset:20992
v_mfma_f32_16x16x32_bf16 v[220:223], v[60:63], a[168:171], v[220:223]
ds_read_b64_tr_b16 a[188:189], v11 offset:20480
v_mfma_f32_16x16x32_bf16 v[240:243], v[60:63], a[172:175], v[240:243]
ds_read_b64_tr_b16 a[190:191], v11 offset:20992
v_mfma_f32_16x16x32_bf16 v[184:187], v[64:67], a[160:163], v[184:187]
v_mfma_f32_16x16x32_bf16 v[204:207], v[64:67], a[164:167], v[204:207]
v_mfma_f32_16x16x32_bf16 v[224:227], v[64:67], a[168:171], v[224:227]
v_mfma_f32_16x16x32_bf16 v[244:247], v[64:67], a[172:175], v[244:247]
v_mfma_f32_16x16x32_bf16 v[188:191], v[68:71], a[160:163], v[188:191]
v_mfma_f32_16x16x32_bf16 v[208:211], v[68:71], a[164:167], v[208:211]
v_mfma_f32_16x16x32_bf16 v[228:231], v[68:71], a[168:171], v[228:231]
v_mfma_f32_16x16x32_bf16 v[248:251], v[68:71], a[172:175], v[248:251]
v_mfma_f32_16x16x32_bf16 v[192:195], v[72:75], a[160:163], v[192:195]
v_mfma_f32_16x16x32_bf16 v[212:215], v[72:75], a[164:167], v[212:215]
v_mfma_f32_16x16x32_bf16 v[232:235], v[72:75], a[168:171], v[232:235]
v_mfma_f32_16x16x32_bf16 v[252:255], v[72:75], a[172:175], v[252:255]
ds_read_b64_tr_b16 a[192:193], v8 offset:0
ds_read_b64_tr_b16 a[194:195], v8 offset:512
ds_read_b64_tr_b16 a[196:197], v9 offset:0
ds_read_b64_tr_b16 a[198:199], v9 offset:512
ds_read_b64_tr_b16 a[200:201], v10 offset:0
ds_read_b64_tr_b16 a[202:203], v10 offset:512
ds_read_b64_tr_b16 a[204:205], v11 offset:0
ds_read_b64_tr_b16 a[206:207], v11 offset:512
s_cmp_ge_u32 s3, 2
s_cbranch_scc1 L_w2_t1
ds_read_b64_tr_b16 a[208:209], v8 offset:4096
ds_read_b64_tr_b16 a[210:211], v8 offset:4608
ds_read_b64_tr_b16 a[212:213], v9 offset:4096
ds_read_b64_tr_b16 a[214:215], v9 offset:4608
ds_read_b64_tr_b16 a[216:217], v10 offset:4096
ds_read_b64_tr_b16 a[218:219], v10 offset:4608
ds_read_b64_tr_b16 a[220:221], v11 offset:4096
ds_read_b64_tr_b16 a[222:223], v11 offset:4608
L_w2_t1:
s_waitcnt vmcnt(0)
s_cmp_ge_u32 s3, 2
s_cbranch_scc1 L_g2_ow
s_waitcnt vmcnt(0)
L_g2_ow:
s_waitcnt lgkmcnt(0)
s_barrier
s_cmp_ge_u32 s3, 2
s_cbranch_scc1 L_g2_o1
v_mfma_f32_16x16x32_bf16 v[196:199], v[36:39], a[212:215], v[196:199]
v_mfma_f32_16x16x32_bf16 v[200:203], v[40:43], a[212:215], v[200:203]
v_mfma_f32_16x16x32_bf16 v[204:207], v[44:47], a[212:215], v[204:207]
v_mfma_f32_16x16x32_bf16 v[208:211], v[48:51], a[212:215], v[208:211]
v_mfma_f32_16x16x32_bf16 v[212:215], v[52:55], a[212:215], v[212:215]
L_g2_o1:
v_mfma_f32_16x16x32_bf16 v[196:199], v[76:79], a[180:183], v[196:199]
v_mfma_f32_16x16x32_bf16 v[200:203], v[80:83], a[180:183], v[200:203]
v_mfma_f32_16x16x32_bf16 v[204:207], v[84:87], a[180:183], v[204:207]
v_mfma_f32_16x16x32_bf16 v[208:211], v[88:91], a[180:183], v[208:211]
v_mfma_f32_16x16x32_bf16 v[212:215], v[92:95], a[180:183], v[212:215]
v_mfma_f32_16x16x32_bf16 v[196:199], v[16:19], a[196:199], v[196:199]
v_mfma_f32_16x16x32_bf16 v[200:203], v[20:23], a[196:199], v[200:203]
v_mfma_f32_16x16x32_bf16 v[204:207], v[24:27], a[196:199], v[204:207]
v_mfma_f32_16x16x32_bf16 v[208:211], v[28:31], a[196:199], v[208:211]
v_mfma_f32_16x16x32_bf16 v[212:215], v[32:35], a[196:199], v[212:215]
s_cmp_ge_u32 s3, 2
s_cbranch_scc1 L_g2_o2
v_mfma_f32_16x16x32_bf16 v[216:219], v[36:39], a[216:219], v[216:219]
v_mfma_f32_16x16x32_bf16 v[220:223], v[40:43], a[216:219], v[220:223]
v_mfma_f32_16x16x32_bf16 v[224:227], v[44:47], a[216:219], v[224:227]
v_mfma_f32_16x16x32_bf16 v[228:231], v[48:51], a[216:219], v[228:231]
v_mfma_f32_16x16x32_bf16 v[232:235], v[52:55], a[216:219], v[232:235]
L_g2_o2:
v_mfma_f32_16x16x32_bf16 v[216:219], v[76:79], a[184:187], v[216:219]
v_mfma_f32_16x16x32_bf16 v[220:223], v[80:83], a[184:187], v[220:223]
v_mfma_f32_16x16x32_bf16 v[224:227], v[84:87], a[184:187], v[224:227]
v_mfma_f32_16x16x32_bf16 v[228:231], v[88:91], a[184:187], v[228:231]
ds_write_b128 v137, v[196:199] offset:0
v_mfma_f32_16x16x32_bf16 v[232:235], v[92:95], a[184:187], v[232:235]
ds_write_b128 v137, v[200:203] offset:1024
v_mfma_f32_16x16x32_bf16 v[216:219], v[16:19], a[200:203], v[216:219]
ds_write_b128 v137, v[204:207] offset:2048
v_mfma_f32_16x16x32_bf16 v[220:223], v[20:23], a[200:203], v[220:223]
ds_write_b128 v137, v[208:211] offset:3072
v_mfma_f32_16x16x32_bf16 v[224:227], v[24:27], a[200:203], v[224:227]
ds_write_b128 v137, v[212:215] offset:4096
v_mfma_f32_16x16x32_bf16 v[228:231], v[28:31], a[200:203], v[228:231]
v_mfma_f32_16x16x32_bf16 v[232:235], v[32:35], a[200:203], v[232:235]
s_cmp_ge_u32 s3, 2
s_cbranch_scc1 L_g2_o3
v_mfma_f32_16x16x32_bf16 v[236:239], v[36:39], a[220:223], v[236:239]
v_mfma_f32_16x16x32_bf16 v[240:243], v[40:43], a[220:223], v[240:243]
v_mfma_f32_16x16x32_bf16 v[244:247], v[44:47], a[220:223], v[244:247]
v_mfma_f32_16x16x32_bf16 v[248:251], v[48:51], a[220:223], v[248:251]
v_mfma_f32_16x16x32_bf16 v[252:255], v[52:55], a[220:223], v[252:255]
L_g2_o3:
v_mfma_f32_16x16x32_bf16 v[236:239], v[76:79], a[188:191], v[236:239]
v_mfma_f32_16x16x32_bf16 v[240:243], v[80:83], a[188:191], v[240:243]
v_mfma_f32_16x16x32_bf16 v[244:247], v[84:87], a[188:191], v[244:247]
v_mfma_f32_16x16x32_bf16 v[248:251], v[88:91], a[188:191], v[248:251]
ds_write_b128 v138, v[216:219] offset:5120
v_mfma_f32_16x16x32_bf16 v[252:255], v[92:95], a[188:191], v[252:255]
ds_write_b128 v138, v[220:223] offset:6144
v_mfma_f32_16x16x32_bf16 v[236:239], v[16:19], a[204:207], v[236:239]
ds_write_b128 v138, v[224:227] offset:7168
v_mfma_f32_16x16x32_bf16 v[240:243], v[20:23], a[204:207], v[240:243]
ds_write_b128 v138, v[228:231] offset:8192
v_mfma_f32_16x16x32_bf16 v[244:247], v[24:27], a[204:207], v[244:247]
ds_write_b128 v138, v[232:235] offset:9216
v_mfma_f32_16x16x32_bf16 v[248:251], v[28:31], a[204:207], v[248:251]
v_mfma_f32_16x16x32_bf16 v[252:255], v[32:35], a[204:207], v[252:255]
s_cmp_ge_u32 s3, 2
s_cbranch_scc1 L_g2_o0
v_mfma_f32_16x16x32_bf16 v[176:179], v[36:39], a[208:211], v[176:179]
v_mfma_f32_16x16x32_bf16 v[180:183], v[40:43], a[208:211], v[180:183]
v_mfma_f32_16x16x32_bf16 v[184:187], v[44:47], a[208:211], v[184:187]
v_mfma_f32_16x16x32_bf16 v[188:191], v[48:51], a[208:211], v[188:191]
v_mfma_f32_16x16x32_bf16 v[192:195], v[52:55], a[208:211], v[192:195]
L_g2_o0:
v_mfma_f32_16x16x32_bf16 v[176:179], v[76:79], a[176:179], v[176:179]
v_mfma_f32_16x16x32_bf16 v[180:183], v[80:83], a[176:179], v[180:183]
v_mfma_f32_16x16x32_bf16 v[184:187], v[84:87], a[176:179], v[184:187]
v_mfma_f32_16x16x32_bf16 v[188:191], v[88:91], a[176:179], v[188:191]
ds_write_b128 v139, v[236:239] offset:10240
v_mfma_f32_16x16x32_bf16 v[192:195], v[92:95], a[176:179], v[192:195]
ds_write_b128 v139, v[240:243] offset:11264
v_mfma_f32_16x16x32_bf16 v[176:179], v[16:19], a[192:195], v[176:179]
ds_write_b128 v140, v[244:247] offset:0
v_mfma_f32_16x16x32_bf16 v[180:183], v[20:23], a[192:195], v[180:183]
ds_write_b128 v140, v[248:251] offset:1024
v_mfma_f32_16x16x32_bf16 v[184:187], v[24:27], a[192:195], v[184:187]
ds_write_b128 v140, v[252:255] offset:2048
v_mfma_f32_16x16x32_bf16 v[188:191], v[28:31], a[192:195], v[188:191]
v_mfma_f32_16x16x32_bf16 v[192:195], v[32:35], a[192:195], v[192:195]
s_waitcnt lgkmcnt(0)
s_barrier
ds_read_b128 v[16:19], v141 offset:0
ds_read_b128 v[36:39], v141 offset:5120
ds_read_b128 v[56:59], v141 offset:10240
ds_read_b128 v[20:23], v141 offset:1024
ds_read_b128 v[40:43], v141 offset:6144
ds_read_b128 v[60:63], v141 offset:11264
ds_read_b128 v[24:27], v141 offset:2048
ds_read_b128 v[44:47], v141 offset:7168
ds_read_b128 v[64:67], v142 offset:0
ds_read_b128 v[28:31], v141 offset:3072
ds_read_b128 v[48:51], v141 offset:8192
ds_read_b128 v[68:71], v142 offset:1024
ds_read_b128 v[32:35], v141 offset:4096
ds_read_b128 v[52:55], v141 offset:9216
ds_read_b128 v[72:75], v142 offset:2048
s_waitcnt lgkmcnt(12)
v_pk_add_f32 v[176:177], v[176:177], v[16:17]
v_pk_add_f32 v[178:179], v[178:179], v[18:19]
v_pk_add_f32 v[176:177], v[176:177], v[36:37]
v_pk_add_f32 v[178:179], v[178:179], v[38:39]
v_pk_add_f32 v[176:177], v[176:177], v[56:57]
v_pk_add_f32 v[178:179], v[178:179], v[58:59]
v_cvt_pk_bf16_f32 v80, v176, v177
v_cvt_pk_bf16_f32 v81, v178, v179
s_waitcnt lgkmcnt(9)
v_pk_add_f32 v[180:181], v[180:181], v[20:21]
v_pk_add_f32 v[182:183], v[182:183], v[22:23]
v_pk_add_f32 v[180:181], v[180:181], v[40:41]
v_pk_add_f32 v[182:183], v[182:183], v[42:43]
v_pk_add_f32 v[180:181], v[180:181], v[60:61]
v_pk_add_f32 v[182:183], v[182:183], v[62:63]
v_cvt_pk_bf16_f32 v82, v180, v181
v_cvt_pk_bf16_f32 v83, v182, v183
s_nop 1
v_permlane16_swap_b32 v80, v82
v_permlane16_swap_b32 v81, v83
buffer_store_dwordx4 v[80:83], v135, s[28:31], s55 offen offset:0
s_waitcnt lgkmcnt(6)
v_pk_add_f32 v[184:185], v[184:185], v[24:25]
v_pk_add_f32 v[186:187], v[186:187], v[26:27]
v_pk_add_f32 v[184:185], v[184:185], v[44:45]
v_pk_add_f32 v[186:187], v[186:187], v[46:47]
v_pk_add_f32 v[184:185], v[184:185], v[64:65]
v_pk_add_f32 v[186:187], v[186:187], v[66:67]
v_cvt_pk_bf16_f32 v84, v184, v185
v_cvt_pk_bf16_f32 v85, v186, v187
s_waitcnt lgkmcnt(3)
v_pk_add_f32 v[188:189], v[188:189], v[28:29]
v_pk_add_f32 v[190:191], v[190:191], v[30:31]
v_pk_add_f32 v[188:189], v[188:189], v[48:49]
v_pk_add_f32 v[190:191], v[190:191], v[50:51]
v_pk_add_f32 v[188:189], v[188:189], v[68:69]
v_pk_add_f32 v[190:191], v[190:191], v[70:71]
v_cvt_pk_bf16_f32 v86, v188, v189
v_cvt_pk_bf16_f32 v87, v190, v191
s_nop 1
v_permlane16_swap_b32 v84, v86
v_permlane16_swap_b32 v85, v87
buffer_store_dwordx4 v[84:87], v135, s[28:31], s55 offen offset:64
s_waitcnt lgkmcnt(0)
v_pk_add_f32 v[192:193], v[192:193], v[32:33]
v_pk_add_f32 v[194:195], v[194:195], v[34:35]
v_pk_add_f32 v[192:193], v[192:193], v[52:53]
v_pk_add_f32 v[194:195], v[194:195], v[54:55]
v_pk_add_f32 v[192:193], v[192:193], v[72:73]
v_pk_add_f32 v[194:195], v[194:195], v[74:75]
v_cvt_pk_bf16_f32 v88, v192, v193
v_cvt_pk_bf16_f32 v89, v194, v195
v_mov_b32 v90, v88
v_mov_b32 v91, v89
s_nop 1
v_permlane16_swap_b32 v88, v90
v_permlane16_swap_b32 v89, v91
buffer_store_dwordx4 v[88:91], v136, s[28:31], s55 offen offset:128
L_end:
s_endpgm
L_code_end:
.section .rodata,"a"
.p2align 6
.amdhsa_kernel standalone__mixer_token_mlp__prompt_kernel
  .amdhsa_next_free_vgpr 512
  .amdhsa_next_free_sgpr 102
  .amdhsa_accum_offset 256
  .amdhsa_group_segment_fixed_size 0
  .amdhsa_kernarg_size 64
  .amdhsa_user_sgpr_count 2
  .amdhsa_user_sgpr_kernarg_segment_ptr 1
  .amdhsa_system_sgpr_workgroup_id_x 1
.end_amdhsa_kernel
```
